```python
import torch

def _softmax(x, axis=-1):
    return torch.softmax(x, dim=axis)

def _gelu(x):
    return torch.nn.functional.gelu(x, approximate='tanh')

def _silu(x):
    return torch.nn.functional.silu(x)

def _sigmoid(x):
    return torch.sigmoid(x)

def _layernorm(x, axis=-1, eps=1e-05):
    m = x.mean(dim=axis, keepdim=True)
    v = x.var(dim=axis, keepdim=True, unbiased=False)
    return (x - m) / torch.sqrt(v + eps)

def _scatter_add(tgt, idx, src, axis=0):
    return tgt.clone().index_add_(axis, idx, src)

def _segment_sum(src, seg, n):
    out = torch.zeros((n,) + src.shape[1:], dtype=src.dtype)
    return out.index_add_(0, seg, src)

def _pad(x, pw):
    flat = tuple((v for pair in reversed(pw) for v in pair))
    return torch.nn.functional.pad(x, flat)
kernel_name = 'standalone__tree_speculative_verify_tree_attention_over_candidate_token_tree__decode'

def setup_inputs():

    _w = lambda a: (lambda t: t.to(torch.bfloat16) if t.is_floating_point() else t)(torch.as_tensor(a))
    B, Hq, Hkv, T, C, D = (2, 32, 32, 1, 8192, 192)
    tree_mask = torch.zeros((B, T, T), dtype=float)
    for b in range(B):
        parent = torch.zeros(T, dtype=torch.int64)
        for i in range(1, T):
            parent[i] = int(torch.randint(0, i, (1,)).item())
        for i in range(T):
            j = i
            tree_mask[b, i, j] = 1.0
            while j > 0:
                j = parent[j]
                tree_mask[b, i, j] = 1.0
    return {'q': _w((lambda *s: torch.randn(*s, dtype=torch.bfloat16) * 0.8)(B, Hq, T, D)), 'k_cache': _w((lambda *s: torch.randn(*s, dtype=torch.bfloat16) * 0.8)(B, Hkv, C, D)), 'v_cache': _w((lambda *s: torch.randn(*s, dtype=torch.bfloat16) * 0.05)(B, Hkv, C, D)), 'k_tree': _w((lambda *s: torch.randn(*s, dtype=torch.bfloat16) * 0.8)(B, Hkv, T, D)), 'v_tree': _w((lambda *s: torch.randn(*s, dtype=torch.bfloat16) * 0.05)(B, Hkv, T, D)), 'tree_mask': _w(tree_mask)}

def reference(q, k_cache, v_cache, k_tree, v_tree, tree_mask):
    B, Hq, T, D = q.shape
    Hkv, C = (k_cache.shape[1], k_cache.shape[2])
    rep = Hq // Hkv
    kc = (lambda x, n, axis: torch.repeat_interleave(x, n, dim=axis))(k_cache, rep, axis=1)
    vc = (lambda x, n, axis: torch.repeat_interleave(x, n, dim=axis))(v_cache, rep, axis=1)
    kt = (lambda x, n, axis: torch.repeat_interleave(x, n, dim=axis))(k_tree, rep, axis=1)
    vt = (lambda x, n, axis: torch.repeat_interleave(x, n, dim=axis))(v_tree, rep, axis=1)
    k = torch.concatenate([kc, kt], axis=2)
    v = torch.concatenate([vc, vt], axis=2)
    scale = D ** (-0.5)
    scores = torch.einsum('bhqd,bhkd->bhqk', q, k) * scale
    ctx_mask = torch.ones((B, 1, T, C), dtype=scores.dtype)
    tm = tree_mask[:, None, :, :].clone()
    full_mask = torch.concatenate([ctx_mask, tm], axis=-1)
    scores = scores + (1.0 - full_mask) * -1000000000.0
    p = _softmax(scores, axis=-1)
    return torch.einsum('bhqk,bhkd->bhqd', p, v)
```

```asm
; @launch grid=(256,1,1) block=(128,1,1) lds=26624
.amdgcn_target "amdgcn-amd-amdhsa--gfx950"
.text
.globl standalone__tree_speculative_verify_tree_attention_over_candidate_token_tree__decode_kernel
.p2align 8
.type standalone__tree_speculative_verify_tree_attention_over_candidate_token_tree__decode_kernel,@function
standalone__tree_speculative_verify_tree_attention_over_candidate_token_tree__decode_kernel:
  s_load_dwordx16 s[4:19], s[0:1], 0
  s_load_dwordx2 s[20:21], s[0:1], 64
  s_cmp_ge_u32 s2, 256
  s_cbranch_scc1 L_end
  v_readfirstlane_b32 s62, v0
  v_and_b32 v0, 63, v0
  s_lshl_b32 s62, s62, 2
  s_add_u32 s2, s2, s62
  s_and_b32 s60, s2, 15
  s_bfe_u32 s61, s2, 0x40004
  s_lshl_b32 s61, s61, 1
  s_lshr_b32 s62, s2, 8
  s_add_u32 s61, s61, s62
  v_and_b32 v74, 7, v0
  v_lshlrev_b32 v74, 4, v74
  v_lshrrev_b32 v2, 3, v0
  v_mul_u32_u24 v11, 384, v2
  v_add_u32 v1, v74, v11
  s_mul_i32 s70, s61, 6144
  s_mul_i32 s62, s60, 3145728
  s_add_u32 s70, s70, s62
  s_add_u32 s68, s70, 150994944
  s_mul_i32 s63, s60, 384
  s_add_u32 s63, s63, 18432
  s_mov_b32 s26, 201326592
  s_mov_b32 s27, 0x20000
  s_mov_b32 s34, 24576
  s_mov_b32 s35, 0x20000
  v_lshlrev_b32 v14, 2, v0
  s_and_b32 s72, s2, 0x100
  v_add_u32 v204, s72, v14
  v_mov_b32 v80, -1
  v_mov_b32 v9, 0
  ds_write_b32 v204, v80 offset:14848
  ds_write_b32 v14, v9 offset:15360
  s_waitcnt lgkmcnt(0)
  s_mov_b32 s32, s4
  s_mov_b32 s33, s5
  s_mov_b32 s24, s6
  s_mov_b32 s25, s7
  buffer_load_dwordx4 v[16:19], v74, s[32:35], s63 offen offset:0
  buffer_load_dwordx4 v[20:23], v74, s[32:35], s63 offen offset:128
  buffer_load_dwordx4 v[24:27], v74, s[32:35], s63 offen offset:256
  s_mov_b32 s23, 196608
  buffer_load_dwordx4 v[108:111], v1, s[24:27], s68 offen offset:0 nt
  buffer_load_dwordx4 v[112:115], v1, s[24:27], s68 offen offset:128 nt
  buffer_load_dwordx4 v[116:119], v1, s[24:27], s68 offen offset:256 nt
  buffer_load_dwordx4 v[120:123], v1, s[24:27], s68 offen offset:3072 nt
  buffer_load_dwordx4 v[124:127], v1, s[24:27], s68 offen offset:3200 nt
  buffer_load_dwordx4 v[128:131], v1, s[24:27], s68 offen offset:3328 nt
  s_add_u32 s68, s68, s23
  buffer_load_dwordx4 v[132:135], v1, s[24:27], s68 offen offset:0 nt
  buffer_load_dwordx4 v[136:139], v1, s[24:27], s68 offen offset:128 nt
  buffer_load_dwordx4 v[140:143], v1, s[24:27], s68 offen offset:256 nt
  buffer_load_dwordx4 v[144:147], v1, s[24:27], s68 offen offset:3072 nt
  buffer_load_dwordx4 v[148:151], v1, s[24:27], s68 offen offset:3200 nt
  buffer_load_dwordx4 v[152:155], v1, s[24:27], s68 offen offset:3328 nt
  s_add_u32 s68, s68, s23
  s_barrier
  s_and_b32 s72, s2, 7
  s_lshl_b32 s72, s72, 12
  s_add_u32 s72, s72, 9437184
  s_add_u32 s52, s20, s72
  s_addc_u32 s53, s21, 0
  s_mov_b32 s54, 256
  s_mov_b32 s55, 0x20000
  buffer_load_dword v68, v14, s[52:55], 0 offen nt
  s_mov_b32 s54, 0
  s_lshr_b32 s99, s2, 3
  s_lshl_b32 s80, s99, 2
  v_lshlrev_b32 v71, 12, v0
  v_add_u32 v71, s80, v71
  s_mov_b32 s72, 0xfff02456
  s_bitcmp1_b32 s2, 3
  s_cselect_b32 s72, 0xfff13457, s72
  v_lshlrev_b32 v75, 2, v2
  v_lshrrev_b32 v75, v75, s72
  v_and_b32 v75, 15, v75
  v_mul_u32_u24 v75, 3072, v75
  s_and_b32 s22, s2, 7
  s_mul_i32 s72, s22, 384
  v_add3_u32 v75, v75, s72, v74
  buffer_load_dwordx4 v[40:43], v75, s[32:35], 0 offen offset:0
  buffer_load_dwordx4 v[44:47], v75, s[32:35], 0 offen offset:128
  buffer_load_dwordx4 v[48:51], v75, s[32:35], 0 offen offset:256
  s_add_u32 s32, s20, 9502720
  s_addc_u32 s33, s21, 0
  s_cmp_lt_u32 s2, 8
  s_cselect_b32 s34, 32, 0
  s_and_b32 s65, s61, 3
  s_lshl_b32 s62, s65, 4
  s_add_u32 s62, s62, s60
  s_lshl_b32 s65, s65, 2
  s_mov_b32 s72, 0x234
  s_bitcmp1_b32 s2, 3
  s_cselect_b32 s72, 0x134, s72
  s_lshr_b32 s65, s72, s65
  s_and_b32 s65, s65, 15
  s_mul_i32 s63, s62, 384
  s_add_u32 s48, s16, s63
  s_addc_u32 s49, s17, 0
  s_mov_b32 s50, 384
  s_mov_b32 s51, 0x20000
  s_lshl_b32 s72, s22, 16
  s_add_u32 s44, s20, s72
  s_addc_u32 s45, s21, 0
  s_mov_b32 s46, 2162688
  s_mov_b32 s47, 0x20000
  s_bfe_u32 s73, s2, 0x10003
  s_lshr_b32 s72, s61, 1
  s_lshl_b32 s72, s72, 1
  s_add_u32 s72, s72, s73
  s_lshl_b32 s72, s72, 1
  s_and_b32 s80, s61, 1
  s_add_u32 s72, s72, s80
  s_mul_i32 s72, s72, 6144
  s_mul_i32 s97, s22, 3145728
  s_add_u32 s97, s97, s72
  s_lshl_b32 s73, s73, 5
  s_add_u32 s96, s73, s61
  s_lshr_b32 s61, s61, 2
  s_lshl_b32 s72, s22, 5
  s_add_u32 s76, s18, s72
  s_addc_u32 s77, s19, 0
  s_mov_b32 s40, s76
  s_mov_b32 s41, s77
  s_mov_b32 s42, 4
  s_mov_b32 s43, 0x20000
  s_mov_b32 s39, 0x20000
  v_lshlrev_b32 v2, 5, v2
  s_lshr_b32 s7, s2, 8
  s_mul_i32 s7, s7, 7424
  v_add_u32 v2, s7, v2
  s_mov_b32 s56, 0x3dd53b95
  s_mov_b32 s71, 15
  v_mov_b32 v3, 0xff800000
  s_mov_b64 s[66:67], 1
  s_mov_b32 s75, 1
  s_mov_b32 s74, 4
  s_mov_b32 s31, 0
  s_mov_b32 s69, 0
  s_mov_b32 s59, 0
  s_getreg_b32 s57, hwreg(HW_REG_XCC_ID, 0, 4)
  s_lshl_b32 s58, s57, 16
  s_mov_b32 s100, 0
  s_mov_b32 s3, 7
  s_waitcnt vmcnt(13)
  buffer_load_dwordx4 v[156:159], v1, s[24:27], s68 offen offset:0 nt
  buffer_load_dwordx4 v[160:163], v1, s[24:27], s68 offen offset:128 nt
  buffer_load_dwordx4 v[164:167], v1, s[24:27], s68 offen offset:256 nt
  s_waitcnt vmcnt(13)
  buffer_load_dwordx4 v[168:171], v1, s[24:27], s68 offen offset:3072 nt
  buffer_load_dwordx4 v[172:175], v1, s[24:27], s68 offen offset:3200 nt
  buffer_load_dwordx4 v[176:179], v1, s[24:27], s68 offen offset:3328 nt
  s_add_u32 s68, s68, s23
  s_waitcnt vmcnt(13)
  buffer_load_dwordx4 v[180:183], v1, s[24:27], s68 offen offset:0 nt
  buffer_load_dwordx4 v[184:187], v1, s[24:27], s68 offen offset:128 nt
  buffer_load_dwordx4 v[188:191], v1, s[24:27], s68 offen offset:256 nt
  s_waitcnt vmcnt(13)
  buffer_load_dwordx4 v[192:195], v1, s[24:27], s68 offen offset:3072 nt
  buffer_load_dwordx4 v[196:199], v1, s[24:27], s68 offen offset:3200 nt
  buffer_load_dwordx4 v[200:203], v1, s[24:27], s68 offen offset:3328 nt
  s_add_u32 s68, s68, s23
  s_branch L_kbody
L_defer:
  s_cmp_eq_u32 s75, 2
  s_cbranch_scc1 L_defer2
  s_load_dword s64, s[14:15], 0
  v_lshlrev_b32 v8, 4, v0
  s_lshl_b32 s72, s65, 7
  s_add_u32 s72, s72, s7
  v_add_u32 v8, s7, v8
  v_add_u32 v9, s72, v74
  s_waitcnt vmcnt(24)
  ds_write_b128 v8, v[40:43] offset:4096
  ds_write_b128 v8, v[44:47] offset:5120
  ds_write_b128 v8, v[48:51] offset:6144
  ds_read_b128 v[40:43], v9 offset:4096
  ds_read_b128 v[44:47], v9 offset:5120
  ds_read_b128 v[48:51], v9 offset:6144
  s_mov_b32 s38, 24576
  s_mov_b32 s36, s10
  s_mov_b32 s37, s11
  buffer_load_dwordx4 v[28:31], v74, s[36:39], s63 offen offset:0
  buffer_load_dwordx4 v[32:35], v74, s[36:39], s63 offen offset:128
  buffer_load_dwordx4 v[36:39], v74, s[36:39], s63 offen offset:256
  v_add_u32 v74, s7, v74
  v_bfe_u32 v9, v0, 4, 1
  v_lshlrev_b32 v9, 8, v9
  v_bfe_u32 v8, v0, 5, 1
  v_lshl_add_u32 v9, v8, 7, v9
  v_and_b32 v8, 7, v0
  v_lshl_add_u32 v9, v8, 4, v9
  s_and_b32 s72, s61, 3
  s_lshl_b32 s72, s72, 2
  s_bfe_u32 s73, s61, 0x10002
  s_lshl_b32 s73, s73, 1
  s_add_u32 s72, s72, s73
  v_add_u32 v9, s72, v9
  s_add_u32 s36, s12, s63
  s_addc_u32 s37, s13, 0
  s_mov_b32 s38, 384
  buffer_load_ushort v75, v9, s[36:39], 0 offen
  v_readlane_b32 s81, v68, s99
  s_mov_b32 s54, 256
  s_mov_b32 s75, 2
  s_mov_b32 s74, 6
  s_add_u32 s80, s81, s75
  s_and_b32 s80, s80, 0xffff
  s_or_b32 s80, s80, s58
  v_mov_b32 v70, s80
  s_cmp_eq_u32 s96, 0
  s_cbranch_scc0 L_kbody
  buffer_load_dword v73, off, s[44:47], 0 offset:12 sc1
  buffer_load_dword v72, v14, s[32:35], 0 offen sc1
  s_lshl_b32 s72, s22, 10
  s_add_u32 s72, s72, 8388608
  s_add_u32 s36, s20, s72
  s_addc_u32 s37, s21, 0
  s_mov_b32 s38, 33792
  v_lshlrev_b32 v8, 4, v0
  s_mov_b32 s72, 0
  buffer_load_dword v88, v8, s[36:39], s72 offen offset:12 sc1
  s_mov_b32 s72, 8192
  buffer_load_dword v89, v8, s[36:39], s72 offen offset:12 sc1
  s_mov_b32 s72, 16384
  buffer_load_dword v90, v8, s[36:39], s72 offen offset:12 sc1
  s_mov_b32 s72, 24576
  buffer_load_dword v91, v8, s[36:39], s72 offen offset:12 sc1
  s_mov_b32 s72, 32768
  buffer_load_dword v92, v8, s[36:39], s72 offen offset:12 sc1
  s_mov_b32 s36, s8
  s_mov_b32 s37, s9
  s_mov_b32 s38, 201326592
  s_add_u32 s72, s70, 150994944
  buffer_load_dword v5, off, s[36:39], s72 nt
  s_branch L_kbody
L_defer2:
  s_waitcnt vmcnt(24)
  v_lshlrev_b32 v75, 16, v75
  v_cmp_le_u32 vcc, 48, v0
  s_nop 0
  v_readfirstlane_b32 s101, v73
  v_cndmask_b32 v75, v75, 1.0, vcc
  v_mov_b32 v5, 0
  s_and_b32 s72, s2, 7
  v_readlane_b32 s98, v72, s72
  v_mov_b32 v76, v72
  v_mov_b32 v77, v72
  v_mov_b32 v78, v72
  v_mov_b32 v79, v72
  s_waitcnt lgkmcnt(0)
  v_dot2c_f32_bf16 v5, v28, v40
  v_dot2c_f32_bf16 v5, v29, v41
  v_dot2c_f32_bf16 v5, v30, v42
  v_dot2c_f32_bf16 v5, v31, v43
  v_dot2c_f32_bf16 v5, v32, v44
  v_dot2c_f32_bf16 v5, v33, v45
  v_dot2c_f32_bf16 v5, v34, v46
  v_dot2c_f32_bf16 v5, v35, v47
  v_dot2c_f32_bf16 v5, v36, v48
  v_dot2c_f32_bf16 v5, v37, v49
  v_dot2c_f32_bf16 v5, v38, v50
  v_dot2c_f32_bf16 v5, v39, v51
  s_lshr_b32 s72, s62, 5
  s_lshl_b32 s72, s72, 4
  s_lshr_b32 s64, s64, s72
  s_lshl_b32 s64, s64, 16
  v_mov_b32 v10, s64
  v_sub_f32 v10, 1.0, v10
  v_mul_f32 v10, 0xd04e79ff, v10
  v_add_f32_dpp v5, v5, v5 quad_perm:[1,0,3,2] row_mask:0xf bank_mask:0xf
  s_nop 1
  v_add_f32_dpp v5, v5, v5 quad_perm:[2,3,0,1] row_mask:0xf bank_mask:0xf
  s_nop 1
  v_add_f32_dpp v5, v5, v5 row_half_mirror row_mask:0xf bank_mask:0xf
  v_add_f32 v5, v5, v10
  s_mov_b32 s64, 43
  s_mov_b32 s54, 256
  s_branch L_kfb
L_kloop:
  s_cmp_le_u32 s75, 2
  s_cbranch_scc1 L_defer
L_kfb:
  s_waitcnt vmcnt(12)
  v_sub_u32 v70, v69, v68
  v_readfirstlane_b32 s74, v69
  v_and_b32 v70, 0xffff, v70
  v_cmp_ne_u32 s[0:1], 0, v70
  v_cmp_le_u32 vcc, s75, v70
  s_add_u32 s75, s75, 1
  s_bcnt1_i32_b64 s72, vcc
  v_cmp_le_u32 vcc, s75, v70
  s_ashr_i32 s74, s74, 20
  s_bcnt1_i32_b64 s73, vcc
  s_bitcmp1_b32 s0, 0
  s_cselect_b32 s74, s74, 0
  s_cmp_lt_u32 s2, 8
  s_cbranch_scc1 L_xak
L_xck:
  s_add_u32 s80, s81, s75
  s_and_b32 s80, s80, 0xffff
  s_or_b32 s80, s80, s58
  s_lshl_b32 s1, s31, 4
  s_or_b32 s80, s80, s1
  v_mov_b32 v70, s80
  s_add_i32 s74, s74, s72
  s_add_i32 s74, s74, s64
  s_mul_i32 s74, s74, 12
  s_ashr_i32 s74, s74, 8
  s_max_i32 s74, s74, 0
  s_min_i32 s74, s74, 6
  s_cmp_ge_u32 s73, 16
  s_cselect_b32 s74, 7, s74
  s_bitcmp1_b32 0x1511, s71
  s_cbranch_scc1 L_wink
L_winrk:
  s_waitcnt lgkmcnt(0)
L_kbody:
  v_mov_b32 v52, 0
  v_mov_b32 v8, 0
  v_mov_b32 v53, 0
  v_mov_b32 v9, 0
  s_waitcnt vmcnt(21)
  v_dot2c_f32_bf16 v52, v108, v16
  v_dot2c_f32_bf16 v8, v109, v17
  v_dot2c_f32_bf16 v52, v110, v18
  v_dot2c_f32_bf16 v8, v111, v19
  v_dot2c_f32_bf16 v52, v112, v20
  v_dot2c_f32_bf16 v8, v113, v21
  v_dot2c_f32_bf16 v52, v114, v22
  v_dot2c_f32_bf16 v8, v115, v23
  v_dot2c_f32_bf16 v52, v116, v24
  v_dot2c_f32_bf16 v8, v117, v25
  v_dot2c_f32_bf16 v52, v118, v26
  v_dot2c_f32_bf16 v8, v119, v27
  s_cmp_ge_u32 s74, 7
  s_cbranch_scc1 L_fw1
  s_waitcnt vmcnt(15)
  s_cmp_ge_u32 s74, 6
  s_cbranch_scc1 L_fw1
  s_waitcnt vmcnt(13)
  s_cmp_ge_u32 s74, 5
  s_cbranch_scc1 L_fw1
  s_waitcnt vmcnt(11)
  s_cmp_ge_u32 s74, 4
  s_cbranch_scc1 L_fw1
  s_waitcnt vmcnt(10)
  s_cmp_ge_u32 s74, 3
  s_cbranch_scc1 L_fw1
  s_waitcnt vmcnt(8)
  s_cmp_ge_u32 s74, 2
  s_cbranch_scc1 L_fw1
  s_waitcnt vmcnt(7)
  s_cmp_ge_u32 s74, 1
  s_cbranch_scc1 L_fw1
  s_waitcnt vmcnt(6)
L_fw1:
  buffer_load_dwordx4 v[108:111], v1, s[24:27], s68 offen offset:0 nt
  buffer_load_dwordx4 v[112:115], v1, s[24:27], s68 offen offset:128 nt
  buffer_load_dwordx4 v[116:119], v1, s[24:27], s68 offen offset:256 nt
  s_waitcnt vmcnt(21)
  v_dot2c_f32_bf16 v53, v120, v16
  v_dot2c_f32_bf16 v9, v121, v17
  v_dot2c_f32_bf16 v53, v122, v18
  v_dot2c_f32_bf16 v9, v123, v19
  v_dot2c_f32_bf16 v53, v124, v20
  v_dot2c_f32_bf16 v9, v125, v21
  v_dot2c_f32_bf16 v53, v126, v22
  v_dot2c_f32_bf16 v9, v127, v23
  v_dot2c_f32_bf16 v53, v128, v24
  v_dot2c_f32_bf16 v9, v129, v25
  v_dot2c_f32_bf16 v53, v130, v26
  v_dot2c_f32_bf16 v9, v131, v27
  s_cmp_ge_u32 s74, 7
  s_cbranch_scc1 L_fw2
  s_waitcnt vmcnt(15)
  s_cmp_ge_u32 s74, 6
  s_cbranch_scc1 L_fw2
  s_waitcnt vmcnt(13)
  s_cmp_ge_u32 s74, 5
  s_cbranch_scc1 L_fw2
  s_waitcnt vmcnt(11)
  s_cmp_ge_u32 s74, 4
  s_cbranch_scc1 L_fw2
  s_waitcnt vmcnt(10)
  s_cmp_ge_u32 s74, 3
  s_cbranch_scc1 L_fw2
  s_waitcnt vmcnt(8)
  s_cmp_ge_u32 s74, 2
  s_cbranch_scc1 L_fw2
  s_waitcnt vmcnt(7)
  s_cmp_ge_u32 s74, 1
  s_cbranch_scc1 L_fw2
  s_waitcnt vmcnt(6)
L_fw2:
  buffer_load_dwordx4 v[120:123], v1, s[24:27], s68 offen offset:3072 nt
  buffer_load_dwordx4 v[124:127], v1, s[24:27], s68 offen offset:3200 nt
  buffer_load_dwordx4 v[128:131], v1, s[24:27], s68 offen offset:3328 nt
  v_add_f32 v52, v52, v8
  v_add_f32 v53, v53, v9
  s_add_u32 s68, s68, s23
  v_add_f32_dpp v52, v52, v52 quad_perm:[1,0,3,2] row_mask:0xf bank_mask:0xf
  v_add_f32_dpp v53, v53, v53 quad_perm:[1,0,3,2] row_mask:0xf bank_mask:0xf
  s_nop 0
  v_add_f32_dpp v52, v52, v52 quad_perm:[2,3,0,1] row_mask:0xf bank_mask:0xf
  v_add_f32_dpp v53, v53, v53 quad_perm:[2,3,0,1] row_mask:0xf bank_mask:0xf
  s_nop 0
  v_add_f32_dpp v52, v52, v52 row_half_mirror row_mask:0xf bank_mask:0xf
  v_add_f32_dpp v53, v53, v53 row_half_mirror row_mask:0xf bank_mask:0xf
  v_max3_f32 v3, v3, v52, v53
  s_cmp_lg_u32 s69, 0
  s_cbranch_scc1 L_xsk0
L_xrk0:
  v_mov_b32 v54, 0
  v_mov_b32 v8, 0
  v_mov_b32 v55, 0
  v_mov_b32 v9, 0
  s_waitcnt vmcnt(21)
  v_dot2c_f32_bf16 v54, v132, v16
  v_dot2c_f32_bf16 v8, v133, v17
  v_dot2c_f32_bf16 v54, v134, v18
  v_dot2c_f32_bf16 v8, v135, v19
  v_dot2c_f32_bf16 v54, v136, v20
  v_dot2c_f32_bf16 v8, v137, v21
  v_dot2c_f32_bf16 v54, v138, v22
  v_dot2c_f32_bf16 v8, v139, v23
  v_dot2c_f32_bf16 v54, v140, v24
  v_dot2c_f32_bf16 v8, v141, v25
  v_dot2c_f32_bf16 v54, v142, v26
  v_dot2c_f32_bf16 v8, v143, v27
  s_cmp_ge_u32 s74, 7
  s_cbranch_scc1 L_fw3
  s_waitcnt vmcnt(15)
  s_cmp_ge_u32 s74, 6
  s_cbranch_scc1 L_fw3
  s_waitcnt vmcnt(13)
  s_cmp_ge_u32 s74, 5
  s_cbranch_scc1 L_fw3
  s_waitcnt vmcnt(11)
  s_cmp_ge_u32 s74, 4
  s_cbranch_scc1 L_fw3
  s_waitcnt vmcnt(10)
  s_cmp_ge_u32 s74, 3
  s_cbranch_scc1 L_fw3
  s_waitcnt vmcnt(8)
  s_cmp_ge_u32 s74, 2
  s_cbranch_scc1 L_fw3
  s_waitcnt vmcnt(7)
  s_cmp_ge_u32 s74, 1
  s_cbranch_scc1 L_fw3
  s_waitcnt vmcnt(6)
L_fw3:
  buffer_load_dwordx4 v[132:135], v1, s[24:27], s68 offen offset:0 nt
  buffer_load_dwordx4 v[136:139], v1, s[24:27], s68 offen offset:128 nt
  buffer_load_dwordx4 v[140:143], v1, s[24:27], s68 offen offset:256 nt
  s_waitcnt vmcnt(21)
  v_dot2c_f32_bf16 v55, v144, v16
  v_dot2c_f32_bf16 v9, v145, v17
  v_dot2c_f32_bf16 v55, v146, v18
  v_dot2c_f32_bf16 v9, v147, v19
  v_dot2c_f32_bf16 v55, v148, v20
  v_dot2c_f32_bf16 v9, v149, v21
  v_dot2c_f32_bf16 v55, v150, v22
  v_dot2c_f32_bf16 v9, v151, v23
  v_dot2c_f32_bf16 v55, v152, v24
  v_dot2c_f32_bf16 v9, v153, v25
  v_dot2c_f32_bf16 v55, v154, v26
  v_dot2c_f32_bf16 v9, v155, v27
  s_cmp_ge_u32 s74, 7
  s_cbranch_scc1 L_fw4
  s_waitcnt vmcnt(15)
  s_cmp_ge_u32 s74, 6
  s_cbranch_scc1 L_fw4
  s_waitcnt vmcnt(13)
  s_cmp_ge_u32 s74, 5
  s_cbranch_scc1 L_fw4
  s_waitcnt vmcnt(11)
  s_cmp_ge_u32 s74, 4
  s_cbranch_scc1 L_fw4
  s_waitcnt vmcnt(10)
  s_cmp_ge_u32 s74, 3
  s_cbranch_scc1 L_fw4
  s_waitcnt vmcnt(8)
  s_cmp_ge_u32 s74, 2
  s_cbranch_scc1 L_fw4
  s_waitcnt vmcnt(7)
  s_cmp_ge_u32 s74, 1
  s_cbranch_scc1 L_fw4
  s_waitcnt vmcnt(6)
L_fw4:
  buffer_load_dwordx4 v[144:147], v1, s[24:27], s68 offen offset:3072 nt
  buffer_load_dwordx4 v[148:151], v1, s[24:27], s68 offen offset:3200 nt
  buffer_load_dwordx4 v[152:155], v1, s[24:27], s68 offen offset:3328 nt
  v_add_f32 v54, v54, v8
  v_add_f32 v55, v55, v9
  s_add_u32 s68, s68, s23
  v_add_f32_dpp v54, v54, v54 quad_perm:[1,0,3,2] row_mask:0xf bank_mask:0xf
  v_add_f32_dpp v55, v55, v55 quad_perm:[1,0,3,2] row_mask:0xf bank_mask:0xf
  s_nop 0
  v_add_f32_dpp v54, v54, v54 quad_perm:[2,3,0,1] row_mask:0xf bank_mask:0xf
  v_add_f32_dpp v55, v55, v55 quad_perm:[2,3,0,1] row_mask:0xf bank_mask:0xf
  s_nop 0
  v_add_f32_dpp v54, v54, v54 row_half_mirror row_mask:0xf bank_mask:0xf
  v_add_f32_dpp v55, v55, v55 row_half_mirror row_mask:0xf bank_mask:0xf
  v_max3_f32 v3, v3, v54, v55
  ds_write_b128 v2, v[52:55] offset:0
  s_cmp_lg_u32 s69, 0
  s_cbranch_scc1 L_xsk1
L_xrk1:
  buffer_load_dword v69, v14, s[52:55], 0 offen nt
  buffer_store_dword v70, v71, s[52:55], 0 offen
  v_mov_b32 v56, 0
  v_mov_b32 v8, 0
  v_mov_b32 v57, 0
  v_mov_b32 v9, 0
  s_waitcnt vmcnt(21)
  v_dot2c_f32_bf16 v56, v156, v16
  v_dot2c_f32_bf16 v8, v157, v17
  v_dot2c_f32_bf16 v56, v158, v18
  v_dot2c_f32_bf16 v8, v159, v19
  v_dot2c_f32_bf16 v56, v160, v20
  v_dot2c_f32_bf16 v8, v161, v21
  v_dot2c_f32_bf16 v56, v162, v22
  v_dot2c_f32_bf16 v8, v163, v23
  v_dot2c_f32_bf16 v56, v164, v24
  v_dot2c_f32_bf16 v8, v165, v25
  v_dot2c_f32_bf16 v56, v166, v26
  v_dot2c_f32_bf16 v8, v167, v27
  s_cmp_ge_u32 s74, 7
  s_cbranch_scc1 L_fw5
  s_waitcnt vmcnt(15)
  s_cmp_ge_u32 s74, 6
  s_cbranch_scc1 L_fw5
  s_waitcnt vmcnt(13)
  s_cmp_ge_u32 s74, 5
  s_cbranch_scc1 L_fw5
  s_waitcnt vmcnt(11)
  s_cmp_ge_u32 s74, 4
  s_cbranch_scc1 L_fw5
  s_waitcnt vmcnt(10)
  s_cmp_ge_u32 s74, 3
  s_cbranch_scc1 L_fw5
  s_waitcnt vmcnt(8)
  s_cmp_ge_u32 s74, 2
  s_cbranch_scc1 L_fw5
  s_waitcnt vmcnt(7)
  s_cmp_ge_u32 s74, 1
  s_cbranch_scc1 L_fw5
  s_waitcnt vmcnt(6)
L_fw5:
  buffer_load_dwordx4 v[156:159], v1, s[24:27], s68 offen offset:0 nt
  buffer_load_dwordx4 v[160:163], v1, s[24:27], s68 offen offset:128 nt
  buffer_load_dwordx4 v[164:167], v1, s[24:27], s68 offen offset:256 nt
  s_waitcnt vmcnt(21)
  v_dot2c_f32_bf16 v57, v168, v16
  v_dot2c_f32_bf16 v9, v169, v17
  v_dot2c_f32_bf16 v57, v170, v18
  v_dot2c_f32_bf16 v9, v171, v19
  v_dot2c_f32_bf16 v57, v172, v20
  v_dot2c_f32_bf16 v9, v173, v21
  v_dot2c_f32_bf16 v57, v174, v22
  v_dot2c_f32_bf16 v9, v175, v23
  v_dot2c_f32_bf16 v57, v176, v24
  v_dot2c_f32_bf16 v9, v177, v25
  v_dot2c_f32_bf16 v57, v178, v26
  v_dot2c_f32_bf16 v9, v179, v27
  s_cmp_ge_u32 s74, 7
  s_cbranch_scc1 L_fw6
  s_waitcnt vmcnt(15)
  s_cmp_ge_u32 s74, 6
  s_cbranch_scc1 L_fw6
  s_waitcnt vmcnt(13)
  s_cmp_ge_u32 s74, 5
  s_cbranch_scc1 L_fw6
  s_waitcnt vmcnt(11)
  s_cmp_ge_u32 s74, 4
  s_cbranch_scc1 L_fw6
  s_waitcnt vmcnt(10)
  s_cmp_ge_u32 s74, 3
  s_cbranch_scc1 L_fw6
  s_waitcnt vmcnt(8)
  s_cmp_ge_u32 s74, 2
  s_cbranch_scc1 L_fw6
  s_waitcnt vmcnt(7)
  s_cmp_ge_u32 s74, 1
  s_cbranch_scc1 L_fw6
  s_waitcnt vmcnt(6)
L_fw6:
  buffer_load_dwordx4 v[168:171], v1, s[24:27], s68 offen offset:3072 nt
  buffer_load_dwordx4 v[172:175], v1, s[24:27], s68 offen offset:3200 nt
  buffer_load_dwordx4 v[176:179], v1, s[24:27], s68 offen offset:3328 nt
  v_add_f32 v56, v56, v8
  v_add_f32 v57, v57, v9
  s_add_u32 s68, s68, s23
  v_add_f32_dpp v56, v56, v56 quad_perm:[1,0,3,2] row_mask:0xf bank_mask:0xf
  v_add_f32_dpp v57, v57, v57 quad_perm:[1,0,3,2] row_mask:0xf bank_mask:0xf
  s_nop 0
  v_add_f32_dpp v56, v56, v56 quad_perm:[2,3,0,1] row_mask:0xf bank_mask:0xf
  v_add_f32_dpp v57, v57, v57 quad_perm:[2,3,0,1] row_mask:0xf bank_mask:0xf
  s_nop 0
  v_add_f32_dpp v56, v56, v56 row_half_mirror row_mask:0xf bank_mask:0xf
  v_add_f32_dpp v57, v57, v57 row_half_mirror row_mask:0xf bank_mask:0xf
  v_max3_f32 v3, v3, v56, v57
  s_cmp_lg_u32 s69, 0
  s_cbranch_scc1 L_xsk2
L_xrk2:
  v_mov_b32 v58, 0
  v_mov_b32 v8, 0
  v_mov_b32 v59, 0
  v_mov_b32 v9, 0
  s_waitcnt vmcnt(21)
  v_dot2c_f32_bf16 v58, v180, v16
  v_dot2c_f32_bf16 v8, v181, v17
  v_dot2c_f32_bf16 v58, v182, v18
  v_dot2c_f32_bf16 v8, v183, v19
  v_dot2c_f32_bf16 v58, v184, v20
  v_dot2c_f32_bf16 v8, v185, v21
  v_dot2c_f32_bf16 v58, v186, v22
  v_dot2c_f32_bf16 v8, v187, v23
  v_dot2c_f32_bf16 v58, v188, v24
  v_dot2c_f32_bf16 v8, v189, v25
  v_dot2c_f32_bf16 v58, v190, v26
  v_dot2c_f32_bf16 v8, v191, v27
  s_cmp_ge_u32 s74, 7
  s_cbranch_scc1 L_fw7
  s_waitcnt vmcnt(15)
  s_cmp_ge_u32 s74, 6
  s_cbranch_scc1 L_fw7
  s_waitcnt vmcnt(13)
  s_cmp_ge_u32 s74, 5
  s_cbranch_scc1 L_fw7
  s_waitcnt vmcnt(11)
  s_cmp_ge_u32 s74, 4
  s_cbranch_scc1 L_fw7
  s_waitcnt vmcnt(10)
  s_cmp_ge_u32 s74, 3
  s_cbranch_scc1 L_fw7
  s_waitcnt vmcnt(8)
  s_cmp_ge_u32 s74, 2
  s_cbranch_scc1 L_fw7
  s_waitcnt vmcnt(7)
  s_cmp_ge_u32 s74, 1
  s_cbranch_scc1 L_fw7
  s_waitcnt vmcnt(6)
L_fw7:
  buffer_load_dwordx4 v[180:183], v1, s[24:27], s68 offen offset:0 nt
  buffer_load_dwordx4 v[184:187], v1, s[24:27], s68 offen offset:128 nt
  buffer_load_dwordx4 v[188:191], v1, s[24:27], s68 offen offset:256 nt
  s_waitcnt vmcnt(21)
  v_dot2c_f32_bf16 v59, v192, v16
  v_dot2c_f32_bf16 v9, v193, v17
  v_dot2c_f32_bf16 v59, v194, v18
  v_dot2c_f32_bf16 v9, v195, v19
  v_dot2c_f32_bf16 v59, v196, v20
  v_dot2c_f32_bf16 v9, v197, v21
  v_dot2c_f32_bf16 v59, v198, v22
  v_dot2c_f32_bf16 v9, v199, v23
  v_dot2c_f32_bf16 v59, v200, v24
  v_dot2c_f32_bf16 v9, v201, v25
  v_dot2c_f32_bf16 v59, v202, v26
  v_dot2c_f32_bf16 v9, v203, v27
  s_cmp_ge_u32 s74, 7
  s_cbranch_scc1 L_fw8
  s_waitcnt vmcnt(16)
  s_cmp_ge_u32 s74, 6
  s_cbranch_scc1 L_fw8
  s_waitcnt vmcnt(14)
  s_cmp_ge_u32 s74, 5
  s_cbranch_scc1 L_fw8
  s_waitcnt vmcnt(12)
  s_cmp_ge_u32 s74, 4
  s_cbranch_scc1 L_fw8
  s_waitcnt vmcnt(11)
  s_cmp_ge_u32 s74, 3
  s_cbranch_scc1 L_fw8
  s_waitcnt vmcnt(9)
  s_cmp_ge_u32 s74, 2
  s_cbranch_scc1 L_fw8
  s_waitcnt vmcnt(8)
  s_cmp_ge_u32 s74, 1
  s_cbranch_scc1 L_fw8
  s_waitcnt vmcnt(7)
L_fw8:
  buffer_load_dwordx4 v[192:195], v1, s[24:27], s68 offen offset:3072 nt
  buffer_load_dwordx4 v[196:199], v1, s[24:27], s68 offen offset:3200 nt
  buffer_load_dwordx4 v[200:203], v1, s[24:27], s68 offen offset:3328 nt
  v_add_f32 v58, v58, v8
  v_add_f32 v59, v59, v9
  s_add_u32 s68, s68, s23
  v_add_f32_dpp v58, v58, v58 quad_perm:[1,0,3,2] row_mask:0xf bank_mask:0xf
  v_add_f32_dpp v59, v59, v59 quad_perm:[1,0,3,2] row_mask:0xf bank_mask:0xf
  s_nop 0
  v_add_f32_dpp v58, v58, v58 quad_perm:[2,3,0,1] row_mask:0xf bank_mask:0xf
  v_add_f32_dpp v59, v59, v59 quad_perm:[2,3,0,1] row_mask:0xf bank_mask:0xf
  s_nop 0
  v_add_f32_dpp v58, v58, v58 row_half_mirror row_mask:0xf bank_mask:0xf
  v_add_f32_dpp v59, v59, v59 row_half_mirror row_mask:0xf bank_mask:0xf
  v_max3_f32 v3, v3, v58, v59
  ds_write_b128 v2, v[56:59] offset:16
  s_cmp_lg_u32 s69, 0
  s_cbranch_scc1 L_xsk3
L_xrk3:
  v_add_u32 v2, 256, v2
  s_bitcmp1_b32 0x1511, s71
  s_cbranch_scc0 L_kmid
  v_add_u32 v74, 128, v74
  ds_read_b128 v[16:19], v74 offset:4096
  ds_read_b128 v[20:23], v74 offset:5120
  ds_read_b128 v[24:27], v74 offset:6144
  v_max_f32_dpp v3, v3, v3 row_ror:8 row_mask:0xf bank_mask:0xf
  v_mov_b32 v8, v3
  v_mov_b32 v9, v3
  s_nop 1
  v_permlane16_swap_b32 v8, v9
  v_max_f32 v3, v8, v9
  v_mov_b32 v8, v3
  v_mov_b32 v9, v3
  s_nop 1
  v_permlane32_swap_b32 v8, v9
  v_max_f32 v3, v8, v9
  v_min_u32 v3, -2, v3
  v_cndmask_b32 v80, v80, v3, s[66:67]
  ds_write_b32 v204, v80 offset:14848
  s_lshl_b64 s[66:67], s[66:67], 1
  v_mov_b32 v3, 0xff800000
  s_cmp_eq_u32 s71, 8
  s_cbranch_scc0 L_kmid
  s_cmp_eq_u32 s96, 0
  s_cbranch_scc0 L_kmid
  s_mul_i32 s30, s101, 0x9e3779b1
  s_add_u32 s30, s30, 0x7f4a7c13
  s_or_b32 s30, s30, 1
L_pick1:
  s_add_u32 s30, s30, 2
  s_cmp_eq_u32 s30, s101
  s_cbranch_scc1 L_pick1
  v_cmp_eq_u32 vcc, s30, v88
  s_cbranch_vccnz L_pick1
  v_cmp_eq_u32 vcc, s30, v89
  s_cbranch_vccnz L_pick1
  v_cmp_eq_u32 vcc, s30, v90
  s_cbranch_vccnz L_pick1
  v_cmp_eq_u32 vcc, s30, v91
  s_cbranch_vccnz L_pick1
  v_cmp_eq_u32 vcc, s30, v92
  s_cbranch_vccnz L_pick1
  s_mov_b32 s78, s30
  s_mov_b32 s79, 0
  v_mov_b32 v8, s78
  v_mov_b32 v9, 0
  buffer_atomic_cmpswap v[8:9], v14, s[40:43], 0 offen sc1
L_kmid:
  s_sub_u32 s71, s71, 1
  s_cbranch_scc0 L_kloop
  v_subrev_u32 v2, 4096, v2
  buffer_load_dword v73, off, s[40:43], 0 sc1
  v_xor_b32 v204, 0x100, v204
  s_mov_b32 s71, 15
  s_mov_b64 s[66:67], 1
  s_mov_b32 s29, 0
  s_lshl_b32 s72, s22, 10
  s_add_u32 s72, s72, 8388608
  s_add_u32 s36, s20, s72
  s_addc_u32 s37, s21, 0
  s_mov_b32 s38, 33792
  s_lshr_b32 s28, s96, 1
  s_lshl_b32 s28, s28, 10
  s_mov_b32 s16, 0
  s_and_b32 s73, s96, 32
  s_lshr_b32 s73, s73, 1
  s_bitcmp1_b32 0x6, s65
  s_cselect_b32 s73, 0, s73
  s_cselect_b32 s101, 1, 0
  s_lshl_b32 s62, s65, 19
  s_and_b32 s72, s61, 7
  s_lshl_b32 s72, s72, 7
  s_add_u32 s62, s62, s72
  s_lshl_b32 s72, s73, 10
  s_add_u32 s62, s62, s72
  s_lshl_b32 s63, s65, 13
  s_lshl_b32 s72, s73, 4
  s_add_u32 s63, s63, s72
  s_waitcnt lgkmcnt(0)
  ds_read_b128 v[60:63], v2 offset:0
  ds_read_b128 v[64:67], v2 offset:16
  v_and_b32 v10, 1, v0
  v_lshlrev_b32 v10, 4, v10
  v_mov_b32 v11, 0xffff
  v_lshlrev_b32 v10, v10, v11
  v_bfe_u32 v11, v0, 1, 2
  v_cmp_eq_u32 vcc, 0, v11
  v_mov_b32 v84, 0x3f803f80
  s_nop 0
  v_cndmask_b32 v24, 0, v10, vcc
  v_cmp_eq_u32 vcc, 1, v11
  v_mov_b32 v85, 0x3f803f80
  s_nop 0
  v_cndmask_b32 v25, 0, v10, vcc
  v_cmp_eq_u32 vcc, 2, v11
  v_mov_b32 v86, 0x3f803f80
  s_nop 0
  v_cndmask_b32 v26, 0, v10, vcc
  v_cmp_eq_u32 vcc, 3, v11
  v_mov_b32 v87, 0x3f803f80
  s_nop 0
  v_cndmask_b32 v27, 0, v10, vcc
  v_lshlrev_b32 v16, 13, v0
  s_lshr_b32 s72, s28, 6
  v_add_u32 v16, s72, v16
  v_lshlrev_b32 v17, 4, v0
  v_lshrrev_b32 v19, 3, v0
  v_and_b32 v18, 0x70, v17
  v_lshl_add_u32 v18, v19, 10, v18
  v_lshlrev_b32 v19, 4, v19
  v_mov_b32 v82, 0
  v_bfe_u32 v20, v0, 4, 1
  v_lshlrev_b32 v20, 8, v20
  v_bfe_u32 v8, v0, 5, 1
  v_lshl_add_u32 v20, v8, 7, v20
  v_and_b32 v8, 7, v0
  v_lshl_add_u32 v20, v8, 4, v20
  s_and_b32 s72, s61, 3
  s_lshl_b32 s72, s72, 2
  s_bfe_u32 s73, s61, 0x10002
  s_lshl_b32 s73, s73, 1
  s_add_u32 s72, s72, s73
  v_add_u32 v20, s72, v20
  s_lshr_b32 s72, s2, 8
  s_lshl_b32 s72, s72, 10
  v_add_u32 v22, s72, v17
  v_mov_b32 v23, 0
L_mxw:
  ds_read_b32 v205, v204 offset:14848
L_mxv:
  s_waitcnt lgkmcnt(0)
L_vinit:
  s_mov_b32 s60, 2
  v_readlane_b32 s73, v205, s29
  v_max_f32 v6, v80, v205
  s_cmp_eq_u32 s73, -1
  s_cbranch_scc1 L_mxw
  v_cndmask_b32 v80, v80, v6, s[66:67]
  s_nop 0
  v_readlane_b32 s72, v80, s29
  v_mov_b64 v[28:29], 0
  v_mov_b64 v[30:31], 0
  v_mov_b64 v[32:33], 0
  v_mov_b64 v[34:35], 0
  v_mov_b64 v[36:37], 0
  v_mov_b64 v[38:39], 0
  v_mov_b64 v[40:41], 0
  v_mov_b64 v[42:43], 0
  v_mov_b32 v4, s72
  v_mul_f32 v4, s56, v4
  v_mov_b64 v[104:105], v[100:101]
  v_mov_b32 v106, v102
  v_mov_b64 v[100:101], v[96:97]
  v_mov_b32 v102, v98
  v_mov_b64 v[96:97], v[92:93]
  v_mov_b32 v98, v94
  v_mov_b64 v[92:93], v[88:89]
  v_mov_b32 v94, v90
L_vloop:
  s_waitcnt lgkmcnt(0)
  v_fma_f32 v52, v60, s56, -v4
  v_fma_f32 v53, v61, s56, -v4
  v_fma_f32 v54, v62, s56, -v4
  v_fma_f32 v55, v63, s56, -v4
  v_fma_f32 v56, v64, s56, -v4
  v_fma_f32 v57, v65, s56, -v4
  v_fma_f32 v58, v66, s56, -v4
  v_fma_f32 v59, v67, s56, -v4
  s_cmp_eq_u32 s71, 0
  s_cbranch_scc1 L_vlast
  s_waitcnt vmcnt(12)
  v_sub_u32 v70, v69, v68
  v_readfirstlane_b32 s74, v69
  v_and_b32 v70, 0xffff, v70
  v_cmp_ne_u32 s[0:1], 0, v70
  v_cmp_le_u32 vcc, s75, v70
  s_add_u32 s75, s75, 1
  s_bcnt1_i32_b64 s72, vcc
  v_cmp_le_u32 vcc, s75, v70
  s_ashr_i32 s74, s74, 20
  s_bcnt1_i32_b64 s73, vcc
  s_bitcmp1_b32 s0, 0
  s_cselect_b32 s74, s74, 0
  v_bfe_u32 v70, v69, 16, 4
  v_cmp_eq_u32 vcc, s57, v70
  s_and_b64 s[0:1], s[0:1], vcc
  s_cmp_eq_u64 s[0:1], -1
  s_cselect_b32 s100, 1, 0
  s_cmp_lt_u32 s2, 8
  s_cbranch_scc1 L_xav
L_xcv:
  s_add_u32 s80, s81, s75
  s_and_b32 s80, s80, 0xffff
  s_or_b32 s80, s80, s58
  s_lshl_b32 s1, s31, 4
  s_or_b32 s80, s80, s1
  v_mov_b32 v70, s80
  s_add_i32 s74, s74, s72
  s_add_i32 s74, s74, s64
  s_mul_i32 s74, s74, 12
  s_ashr_i32 s74, s74, 8
  s_max_i32 s74, s74, 0
  s_min_i32 s74, s74, 6
  s_cmp_ge_u32 s73, 16
  s_cselect_b32 s74, 7, s74
  s_cmp_le_u32 s71, 1
  s_cselect_b32 s74, 7, s74
  s_add_u32 s74, s74, s60
  s_bitcmp1_b32 0x1511, s71
  s_cbranch_scc1 L_winv
L_winrv:
  v_add_u32 v2, 256, v2
  ds_read_b128 v[60:63], v2 offset:0
  ds_read_b128 v[64:67], v2 offset:16
  v_exp_f32 v52, v52
  v_exp_f32 v53, v53
  s_nop 0
  v_cvt_pk_bf16_f32 v6, v52, v52
  v_cvt_pk_bf16_f32 v7, v53, v53
  v_and_b32 v44, v24, v6
  v_and_b32 v45, v25, v6
  v_and_b32 v46, v26, v6
  v_and_b32 v47, v27, v6
  v_and_b32 v48, v24, v7
  v_and_b32 v49, v25, v7
  v_and_b32 v50, v26, v7
  v_and_b32 v51, v27, v7
  v_mfma_f32_16x16x32_bf16 v[40:43], v[44:47], v[84:87], v[40:43]
  s_waitcnt vmcnt(21)
  v_mfma_f32_16x16x32_bf16 v[28:31], v[44:47], v[108:111], v[28:31]
  v_mfma_f32_16x16x32_bf16 v[32:35], v[44:47], v[112:115], v[32:35]
  v_mfma_f32_16x16x32_bf16 v[36:39], v[44:47], v[116:119], v[36:39]
  v_mfma_f32_16x16x32_bf16 v[40:43], v[48:51], v[84:87], v[40:43]
  s_cmp_ge_u32 s74, 7
  s_cbranch_scc1 L_fw9
  s_waitcnt vmcnt(15)
  s_cmp_ge_u32 s74, 6
  s_cbranch_scc1 L_fw9
  s_waitcnt vmcnt(13)
  s_cmp_ge_u32 s74, 5
  s_cbranch_scc1 L_fw9
  s_waitcnt vmcnt(11)
  s_cmp_ge_u32 s74, 4
  s_cbranch_scc1 L_fw9
  s_waitcnt vmcnt(10)
  s_cmp_ge_u32 s74, 3
  s_cbranch_scc1 L_fw9
  s_waitcnt vmcnt(8)
  s_cmp_ge_u32 s74, 2
  s_cbranch_scc1 L_fw9
  s_waitcnt vmcnt(7)
  s_cmp_ge_u32 s74, 1
  s_cbranch_scc1 L_fw9
  s_waitcnt vmcnt(6)
L_fw9:
  buffer_load_dwordx4 v[108:111], v1, s[24:27], s68 offen offset:0 nt
  buffer_load_dwordx4 v[112:115], v1, s[24:27], s68 offen offset:128 nt
  buffer_load_dwordx4 v[116:119], v1, s[24:27], s68 offen offset:256 nt
  s_waitcnt vmcnt(21)
  v_mfma_f32_16x16x32_bf16 v[28:31], v[48:51], v[120:123], v[28:31]
  v_mfma_f32_16x16x32_bf16 v[32:35], v[48:51], v[124:127], v[32:35]
  v_mfma_f32_16x16x32_bf16 v[36:39], v[48:51], v[128:131], v[36:39]
  s_cmp_ge_u32 s74, 7
  s_cbranch_scc1 L_fw10
  s_waitcnt vmcnt(15)
  s_cmp_ge_u32 s74, 6
  s_cbranch_scc1 L_fw10
  s_waitcnt vmcnt(13)
  s_cmp_ge_u32 s74, 5
  s_cbranch_scc1 L_fw10
  s_waitcnt vmcnt(11)
  s_cmp_ge_u32 s74, 4
  s_cbranch_scc1 L_fw10
  s_waitcnt vmcnt(10)
  s_cmp_ge_u32 s74, 3
  s_cbranch_scc1 L_fw10
  s_waitcnt vmcnt(8)
  s_cmp_ge_u32 s74, 2
  s_cbranch_scc1 L_fw10
  s_waitcnt vmcnt(7)
  s_cmp_ge_u32 s74, 1
  s_cbranch_scc1 L_fw10
  s_waitcnt vmcnt(6)
L_fw10:
  buffer_load_dwordx4 v[120:123], v1, s[24:27], s68 offen offset:3072 nt
  buffer_load_dwordx4 v[124:127], v1, s[24:27], s68 offen offset:3200 nt
  buffer_load_dwordx4 v[128:131], v1, s[24:27], s68 offen offset:3328 nt
  s_add_u32 s68, s68, s23
  s_cmp_lg_u32 s69, 0
  s_cbranch_scc1 L_xsv0
L_xrv0:
  v_exp_f32 v54, v54
  v_exp_f32 v55, v55
  s_nop 0
  v_cvt_pk_bf16_f32 v6, v54, v54
  v_cvt_pk_bf16_f32 v7, v55, v55
  v_and_b32 v44, v24, v6
  v_and_b32 v45, v25, v6
  v_and_b32 v46, v26, v6
  v_and_b32 v47, v27, v6
  v_and_b32 v48, v24, v7
  v_and_b32 v49, v25, v7
  v_and_b32 v50, v26, v7
  v_and_b32 v51, v27, v7
  v_mfma_f32_16x16x32_bf16 v[40:43], v[44:47], v[84:87], v[40:43]
  s_waitcnt vmcnt(21)
  v_mfma_f32_16x16x32_bf16 v[28:31], v[44:47], v[132:135], v[28:31]
  v_mfma_f32_16x16x32_bf16 v[32:35], v[44:47], v[136:139], v[32:35]
  v_mfma_f32_16x16x32_bf16 v[36:39], v[44:47], v[140:143], v[36:39]
  v_mfma_f32_16x16x32_bf16 v[40:43], v[48:51], v[84:87], v[40:43]
  s_cmp_ge_u32 s74, 7
  s_cbranch_scc1 L_fw11
  s_waitcnt vmcnt(15)
  s_cmp_ge_u32 s74, 6
  s_cbranch_scc1 L_fw11
  s_waitcnt vmcnt(13)
  s_cmp_ge_u32 s74, 5
  s_cbranch_scc1 L_fw11
  s_waitcnt vmcnt(11)
  s_cmp_ge_u32 s74, 4
  s_cbranch_scc1 L_fw11
  s_waitcnt vmcnt(10)
  s_cmp_ge_u32 s74, 3
  s_cbranch_scc1 L_fw11
  s_waitcnt vmcnt(8)
  s_cmp_ge_u32 s74, 2
  s_cbranch_scc1 L_fw11
  s_waitcnt vmcnt(7)
  s_cmp_ge_u32 s74, 1
  s_cbranch_scc1 L_fw11
  s_waitcnt vmcnt(6)
L_fw11:
  buffer_load_dwordx4 v[132:135], v1, s[24:27], s68 offen offset:0 nt
  buffer_load_dwordx4 v[136:139], v1, s[24:27], s68 offen offset:128 nt
  buffer_load_dwordx4 v[140:143], v1, s[24:27], s68 offen offset:256 nt
  s_waitcnt vmcnt(21)
  v_mfma_f32_16x16x32_bf16 v[28:31], v[48:51], v[144:147], v[28:31]
  v_mfma_f32_16x16x32_bf16 v[32:35], v[48:51], v[148:151], v[32:35]
  v_mfma_f32_16x16x32_bf16 v[36:39], v[48:51], v[152:155], v[36:39]
  s_cmp_ge_u32 s74, 7
  s_cbranch_scc1 L_fw12
  s_waitcnt vmcnt(15)
  s_cmp_ge_u32 s74, 6
  s_cbranch_scc1 L_fw12
  s_waitcnt vmcnt(13)
  s_cmp_ge_u32 s74, 5
  s_cbranch_scc1 L_fw12
  s_waitcnt vmcnt(11)
  s_cmp_ge_u32 s74, 4
  s_cbranch_scc1 L_fw12
  s_waitcnt vmcnt(10)
  s_cmp_ge_u32 s74, 3
  s_cbranch_scc1 L_fw12
  s_waitcnt vmcnt(8)
  s_cmp_ge_u32 s74, 2
  s_cbranch_scc1 L_fw12
  s_waitcnt vmcnt(7)
  s_cmp_ge_u32 s74, 1
  s_cbranch_scc1 L_fw12
  s_waitcnt vmcnt(6)
L_fw12:
  buffer_load_dwordx4 v[144:147], v1, s[24:27], s68 offen offset:3072 nt
  buffer_load_dwordx4 v[148:151], v1, s[24:27], s68 offen offset:3200 nt
  buffer_load_dwordx4 v[152:155], v1, s[24:27], s68 offen offset:3328 nt
  s_add_u32 s68, s68, s23
  s_cmp_lg_u32 s69, 0
  s_cbranch_scc1 L_xsv1
L_xrv1:
  s_sub_u32 s74, s74, s60
  s_mov_b32 s60, 0
  buffer_load_dword v69, v14, s[52:55], 0 offen nt
  buffer_store_dword v70, v71, s[52:55], 0 offen
  v_exp_f32 v56, v56
  v_exp_f32 v57, v57
  s_nop 0
  v_cvt_pk_bf16_f32 v6, v56, v56
  v_cvt_pk_bf16_f32 v7, v57, v57
  v_and_b32 v44, v24, v6
  v_and_b32 v45, v25, v6
  v_and_b32 v46, v26, v6
  v_and_b32 v47, v27, v6
  v_and_b32 v48, v24, v7
  v_and_b32 v49, v25, v7
  v_and_b32 v50, v26, v7
  v_and_b32 v51, v27, v7
  v_mfma_f32_16x16x32_bf16 v[40:43], v[44:47], v[84:87], v[40:43]
  s_waitcnt vmcnt(21)
  v_mfma_f32_16x16x32_bf16 v[28:31], v[44:47], v[156:159], v[28:31]
  v_mfma_f32_16x16x32_bf16 v[32:35], v[44:47], v[160:163], v[32:35]
  v_mfma_f32_16x16x32_bf16 v[36:39], v[44:47], v[164:167], v[36:39]
  v_mfma_f32_16x16x32_bf16 v[40:43], v[48:51], v[84:87], v[40:43]
  s_cmp_ge_u32 s74, 7
  s_cbranch_scc1 L_fw13
  s_waitcnt vmcnt(15)
  s_cmp_ge_u32 s74, 6
  s_cbranch_scc1 L_fw13
  s_waitcnt vmcnt(13)
  s_cmp_ge_u32 s74, 5
  s_cbranch_scc1 L_fw13
  s_waitcnt vmcnt(11)
  s_cmp_ge_u32 s74, 4
  s_cbranch_scc1 L_fw13
  s_waitcnt vmcnt(10)
  s_cmp_ge_u32 s74, 3
  s_cbranch_scc1 L_fw13
  s_waitcnt vmcnt(8)
  s_cmp_ge_u32 s74, 2
  s_cbranch_scc1 L_fw13
  s_waitcnt vmcnt(7)
  s_cmp_ge_u32 s74, 1
  s_cbranch_scc1 L_fw13
  s_waitcnt vmcnt(6)
L_fw13:
  buffer_load_dwordx4 v[156:159], v1, s[24:27], s68 offen offset:0 nt
  buffer_load_dwordx4 v[160:163], v1, s[24:27], s68 offen offset:128 nt
  buffer_load_dwordx4 v[164:167], v1, s[24:27], s68 offen offset:256 nt
  s_waitcnt vmcnt(21)
  v_mfma_f32_16x16x32_bf16 v[28:31], v[48:51], v[168:171], v[28:31]
  v_mfma_f32_16x16x32_bf16 v[32:35], v[48:51], v[172:175], v[32:35]
  v_mfma_f32_16x16x32_bf16 v[36:39], v[48:51], v[176:179], v[36:39]
  s_cmp_ge_u32 s74, 7
  s_cbranch_scc1 L_fw14
  s_waitcnt vmcnt(15)
  s_cmp_ge_u32 s74, 6
  s_cbranch_scc1 L_fw14
  s_waitcnt vmcnt(13)
  s_cmp_ge_u32 s74, 5
  s_cbranch_scc1 L_fw14
  s_waitcnt vmcnt(11)
  s_cmp_ge_u32 s74, 4
  s_cbranch_scc1 L_fw14
  s_waitcnt vmcnt(10)
  s_cmp_ge_u32 s74, 3
  s_cbranch_scc1 L_fw14
  s_waitcnt vmcnt(8)
  s_cmp_ge_u32 s74, 2
  s_cbranch_scc1 L_fw14
  s_waitcnt vmcnt(7)
  s_cmp_ge_u32 s74, 1
  s_cbranch_scc1 L_fw14
  s_waitcnt vmcnt(6)
L_fw14:
  buffer_load_dwordx4 v[168:171], v1, s[24:27], s68 offen offset:3072 nt
  buffer_load_dwordx4 v[172:175], v1, s[24:27], s68 offen offset:3200 nt
  buffer_load_dwordx4 v[176:179], v1, s[24:27], s68 offen offset:3328 nt
  s_add_u32 s68, s68, s23
  s_cmp_lg_u32 s69, 0
  s_cbranch_scc1 L_xsv2
L_xrv2:
  v_exp_f32 v58, v58
  v_exp_f32 v59, v59
  s_nop 0
  v_cvt_pk_bf16_f32 v6, v58, v58
  v_cvt_pk_bf16_f32 v7, v59, v59
  v_and_b32 v44, v24, v6
  v_and_b32 v45, v25, v6
  v_and_b32 v46, v26, v6
  v_and_b32 v47, v27, v6
  v_and_b32 v48, v24, v7
  v_and_b32 v49, v25, v7
  v_and_b32 v50, v26, v7
  v_and_b32 v51, v27, v7
  v_mfma_f32_16x16x32_bf16 v[40:43], v[44:47], v[84:87], v[40:43]
  s_waitcnt vmcnt(21)
  v_mfma_f32_16x16x32_bf16 v[28:31], v[44:47], v[180:183], v[28:31]
  v_mfma_f32_16x16x32_bf16 v[32:35], v[44:47], v[184:187], v[32:35]
  v_mfma_f32_16x16x32_bf16 v[36:39], v[44:47], v[188:191], v[36:39]
  v_mfma_f32_16x16x32_bf16 v[40:43], v[48:51], v[84:87], v[40:43]
  s_cmp_ge_u32 s74, 7
  s_cbranch_scc1 L_fw15
  s_waitcnt vmcnt(15)
  s_cmp_ge_u32 s74, 6
  s_cbranch_scc1 L_fw15
  s_waitcnt vmcnt(13)
  s_cmp_ge_u32 s74, 5
  s_cbranch_scc1 L_fw15
  s_waitcnt vmcnt(11)
  s_cmp_ge_u32 s74, 4
  s_cbranch_scc1 L_fw15
  s_waitcnt vmcnt(10)
  s_cmp_ge_u32 s74, 3
  s_cbranch_scc1 L_fw15
  s_waitcnt vmcnt(8)
  s_cmp_ge_u32 s74, 2
  s_cbranch_scc1 L_fw15
  s_waitcnt vmcnt(7)
  s_cmp_ge_u32 s74, 1
  s_cbranch_scc1 L_fw15
  s_waitcnt vmcnt(6)
L_fw15:
  buffer_load_dwordx4 v[180:183], v1, s[24:27], s68 offen offset:0 nt
  buffer_load_dwordx4 v[184:187], v1, s[24:27], s68 offen offset:128 nt
  buffer_load_dwordx4 v[188:191], v1, s[24:27], s68 offen offset:256 nt
  s_waitcnt vmcnt(21)
  v_mfma_f32_16x16x32_bf16 v[28:31], v[48:51], v[192:195], v[28:31]
  v_mfma_f32_16x16x32_bf16 v[32:35], v[48:51], v[196:199], v[32:35]
  v_mfma_f32_16x16x32_bf16 v[36:39], v[48:51], v[200:203], v[36:39]
  s_cmp_ge_u32 s74, 7
  s_cbranch_scc1 L_fw16
  s_waitcnt vmcnt(16)
  s_cmp_ge_u32 s74, 6
  s_cbranch_scc1 L_fw16
  s_waitcnt vmcnt(14)
  s_cmp_ge_u32 s74, 5
  s_cbranch_scc1 L_fw16
  s_waitcnt vmcnt(12)
  s_cmp_ge_u32 s74, 4
  s_cbranch_scc1 L_fw16
  s_waitcnt vmcnt(11)
  s_cmp_ge_u32 s74, 3
  s_cbranch_scc1 L_fw16
  s_waitcnt vmcnt(9)
  s_cmp_ge_u32 s74, 2
  s_cbranch_scc1 L_fw16
  s_waitcnt vmcnt(8)
  s_cmp_ge_u32 s74, 1
  s_cbranch_scc1 L_fw16
  s_waitcnt vmcnt(7)
L_fw16:
  buffer_load_dwordx4 v[192:195], v1, s[24:27], s68 offen offset:3072 nt
  buffer_load_dwordx4 v[196:199], v1, s[24:27], s68 offen offset:3200 nt
  buffer_load_dwordx4 v[200:203], v1, s[24:27], s68 offen offset:3328 nt
  s_add_u32 s68, s68, s23
  s_cmp_lg_u32 s69, 0
  s_cbranch_scc1 L_xsv3
L_xrv3:
  s_bitcmp1_b32 0x1511, s71
  s_cbranch_scc1 L_flush0
  s_sub_u32 s71, s71, 1
  s_branch L_vloop
L_vlast:
  s_branch L_pf
L_nopf:
  v_exp_f32 v52, v52
  v_exp_f32 v53, v53
  s_nop 0
  v_cvt_pk_bf16_f32 v6, v52, v52
  v_cvt_pk_bf16_f32 v7, v53, v53
  v_and_b32 v44, v24, v6
  v_and_b32 v45, v25, v6
  v_and_b32 v46, v26, v6
  v_and_b32 v47, v27, v6
  v_and_b32 v48, v24, v7
  v_and_b32 v49, v25, v7
  v_and_b32 v50, v26, v7
  v_and_b32 v51, v27, v7
  v_mfma_f32_16x16x32_bf16 v[40:43], v[44:47], v[84:87], v[40:43]
  s_waitcnt vmcnt(29)
  v_mfma_f32_16x16x32_bf16 v[28:31], v[44:47], v[108:111], v[28:31]
  v_mfma_f32_16x16x32_bf16 v[32:35], v[44:47], v[112:115], v[32:35]
  v_mfma_f32_16x16x32_bf16 v[36:39], v[44:47], v[116:119], v[36:39]
  v_mfma_f32_16x16x32_bf16 v[40:43], v[48:51], v[84:87], v[40:43]
  s_waitcnt vmcnt(26)
  v_mfma_f32_16x16x32_bf16 v[28:31], v[48:51], v[120:123], v[28:31]
  v_mfma_f32_16x16x32_bf16 v[32:35], v[48:51], v[124:127], v[32:35]
  v_mfma_f32_16x16x32_bf16 v[36:39], v[48:51], v[128:131], v[36:39]
  v_exp_f32 v54, v54
  v_exp_f32 v55, v55
  s_nop 0
  v_cvt_pk_bf16_f32 v6, v54, v54
  v_cvt_pk_bf16_f32 v7, v55, v55
  v_and_b32 v44, v24, v6
  v_and_b32 v45, v25, v6
  v_and_b32 v46, v26, v6
  v_and_b32 v47, v27, v6
  v_and_b32 v48, v24, v7
  v_and_b32 v49, v25, v7
  v_and_b32 v50, v26, v7
  v_and_b32 v51, v27, v7
  v_mfma_f32_16x16x32_bf16 v[40:43], v[44:47], v[84:87], v[40:43]
  s_waitcnt vmcnt(23)
  v_mfma_f32_16x16x32_bf16 v[28:31], v[44:47], v[132:135], v[28:31]
  v_mfma_f32_16x16x32_bf16 v[32:35], v[44:47], v[136:139], v[32:35]
  v_mfma_f32_16x16x32_bf16 v[36:39], v[44:47], v[140:143], v[36:39]
  v_mfma_f32_16x16x32_bf16 v[40:43], v[48:51], v[84:87], v[40:43]
  s_waitcnt vmcnt(20)
  v_mfma_f32_16x16x32_bf16 v[28:31], v[48:51], v[144:147], v[28:31]
  v_mfma_f32_16x16x32_bf16 v[32:35], v[48:51], v[148:151], v[32:35]
  v_mfma_f32_16x16x32_bf16 v[36:39], v[48:51], v[152:155], v[36:39]
  v_exp_f32 v56, v56
  v_exp_f32 v57, v57
  s_nop 0
  v_cvt_pk_bf16_f32 v6, v56, v56
  v_cvt_pk_bf16_f32 v7, v57, v57
  v_and_b32 v44, v24, v6
  v_and_b32 v45, v25, v6
  v_and_b32 v46, v26, v6
  v_and_b32 v47, v27, v6
  v_and_b32 v48, v24, v7
  v_and_b32 v49, v25, v7
  v_and_b32 v50, v26, v7
  v_and_b32 v51, v27, v7
  v_mfma_f32_16x16x32_bf16 v[40:43], v[44:47], v[84:87], v[40:43]
  s_waitcnt vmcnt(17)
  v_mfma_f32_16x16x32_bf16 v[28:31], v[44:47], v[156:159], v[28:31]
  v_mfma_f32_16x16x32_bf16 v[32:35], v[44:47], v[160:163], v[32:35]
  v_mfma_f32_16x16x32_bf16 v[36:39], v[44:47], v[164:167], v[36:39]
  v_mfma_f32_16x16x32_bf16 v[40:43], v[48:51], v[84:87], v[40:43]
  s_waitcnt vmcnt(14)
  v_mfma_f32_16x16x32_bf16 v[28:31], v[48:51], v[168:171], v[28:31]
  v_mfma_f32_16x16x32_bf16 v[32:35], v[48:51], v[172:175], v[32:35]
  v_mfma_f32_16x16x32_bf16 v[36:39], v[48:51], v[176:179], v[36:39]
  v_exp_f32 v58, v58
  v_exp_f32 v59, v59
  s_nop 0
  v_cvt_pk_bf16_f32 v6, v58, v58
  v_cvt_pk_bf16_f32 v7, v59, v59
  v_and_b32 v44, v24, v6
  v_and_b32 v45, v25, v6
  v_and_b32 v46, v26, v6
  v_and_b32 v47, v27, v6
  v_and_b32 v48, v24, v7
  v_and_b32 v49, v25, v7
  v_and_b32 v50, v26, v7
  v_and_b32 v51, v27, v7
  v_mfma_f32_16x16x32_bf16 v[40:43], v[44:47], v[84:87], v[40:43]
  s_waitcnt vmcnt(11)
  v_mfma_f32_16x16x32_bf16 v[28:31], v[44:47], v[180:183], v[28:31]
  v_mfma_f32_16x16x32_bf16 v[32:35], v[44:47], v[184:187], v[32:35]
  v_mfma_f32_16x16x32_bf16 v[36:39], v[44:47], v[188:191], v[36:39]
  v_mfma_f32_16x16x32_bf16 v[40:43], v[48:51], v[84:87], v[40:43]
  s_waitcnt vmcnt(8)
  v_mfma_f32_16x16x32_bf16 v[28:31], v[48:51], v[192:195], v[28:31]
  v_mfma_f32_16x16x32_bf16 v[32:35], v[48:51], v[196:199], v[32:35]
  v_mfma_f32_16x16x32_bf16 v[36:39], v[48:51], v[200:203], v[36:39]
  s_nop 1
L_flush0:
  v_readfirstlane_b32 s30, v73
  s_add_u32 s29, s29, 1
  v_permlane32_swap_b32 v40, v41
  v_mov_b32 v7, 1
  v_mov_b32 v83, s30
  v_add_f32 v91, v40, v41
  v_permlane32_swap_b32 v28, v29
  v_permlane32_swap_b32 v30, v31
  v_permlane32_swap_b32 v32, v33
  v_permlane32_swap_b32 v34, v35
  v_permlane32_swap_b32 v36, v37
  v_permlane32_swap_b32 v38, v39
  v_xor_b32 v8, 0x400, v22
  s_nop 0
  v_add_f32_dpp v88, v29, v28 row_ror:8 row_mask:0xf bank_mask:0x3
  v_add_f32_dpp v88, v30, v31 row_ror:8 row_mask:0xf bank_mask:0xc
  v_add_f32_dpp v89, v33, v32 row_ror:8 row_mask:0xf bank_mask:0x3
  v_add_f32_dpp v89, v34, v35 row_ror:8 row_mask:0xf bank_mask:0xc
  v_add_f32_dpp v90, v37, v36 row_ror:8 row_mask:0xf bank_mask:0x3
  v_add_f32_dpp v90, v38, v39 row_ror:8 row_mask:0xf bank_mask:0xc
  ds_write_b128 v22, v[88:91] offset:16384
  s_mov_b64 exec, 1
  ds_add_rtn_u32 v6, v23, v7 offset:15360
  s_mov_b64 exec, -1
  ds_read_b128 v[44:47], v8 offset:16384
  ds_read_b32 v205, v204 offset:14848
  v_add_u32 v22, 0x800, v22
  v_add_u32 v23, 4, v23
  s_waitcnt lgkmcnt(0)
  v_readfirstlane_b32 s72, v6
  v_add_f32 v88, v88, v44
  v_add_f32 v89, v89, v45
  v_add_f32 v90, v90, v46
  v_add_f32 v91, v91, v47
  s_cmp_eq_u32 s72, 0
  s_cbranch_scc1 L_nost
  v_cndmask_b32 v81, v81, v91, s[66:67]
  v_mov_b32 v91, s30
  s_or_b32 s16, s16, s66
  s_cmp_eq_u32 s30, 0
  s_cbranch_scc1 L_nost
  buffer_store_dwordx4 v[88:91], v17, s[44:47], s28 offen
  s_mov_b64 exec, s[66:67]
  buffer_store_dwordx4 v[80:83], v16, s[36:39], 0 offen
  s_mov_b64 exec, -1
L_nost:
  s_lshl_b64 s[66:67], s[66:67], 1
  s_add_u32 s28, s28, 524288
  s_sub_u32 s71, s71, 1
  s_cbranch_scc0 L_vinit
  s_cmp_eq_u32 s30, 0
  s_cselect_b32 s100, 0, s100
  s_mov_b32 s73, 0x400000
  s_cmp_eq_u32 s100, 0
  s_cbranch_scc1 L_slow
L_comb:
  s_cmp_eq_u32 s101, 1
  s_cbranch_scc1 L_poll4
L_poll2:
  s_cmp_lt_u32 s73, 0x3fffc0
  s_cbranch_scc1 L_polls2
  buffer_load_dwordx4 v[116:119], v19, s[36:39], s63 offen offset:0 nt
  buffer_load_dwordx4 v[120:123], v19, s[36:39], s63 offen offset:128 nt
  s_add_u32 s72, s62, 0
  buffer_load_dwordx4 v[108:111], v18, s[44:47], s72 offen nt
  s_add_u32 s72, s62, 8192
  buffer_load_dwordx4 v[112:115], v18, s[44:47], s72 offen nt
L_pollc2:
  s_sub_u32 s73, s73, 1
  s_cbranch_scc1 L_fin
  s_waitcnt vmcnt(2)
  v_max3_f32 v7, v5, v116, v120
  v_xor_b32 v119, s30, v119
  v_xor_b32 v123, s30, v123
  v_max_f32_dpp v7, v7, v7 row_ror:8 row_mask:0xf bank_mask:0xf
  v_mov_b32 v8, v7
  v_mov_b32 v9, v7
  s_nop 1
  v_permlane16_swap_b32 v8, v9
  v_max_f32 v7, v8, v9
  v_mov_b32 v8, v7
  v_mov_b32 v9, v7
  s_nop 1
  v_permlane32_swap_b32 v8, v9
  v_max_f32 v7, v8, v9
  v_mul_f32 v7, s56, v7
  v_fma_f32 v116, v116, s56, -v7
  v_fma_f32 v120, v120, s56, -v7
  v_fma_f32 v7, v5, s56, -v7
  v_exp_f32 v116, v116
  v_exp_f32 v120, v120
  v_exp_f32 v7, v7
  v_or_b32 v6, v119, v123
  v_mul_f32 v13, v116, v117
  v_fmac_f32 v13, v120, v121
  s_waitcnt vmcnt(0)
  v_xor_b32 v111, s30, v111
  v_xor_b32 v115, s30, v115
  v_or3_b32 v6, v6, v111, v115
  v_cmp_ne_u32 vcc, 0, v6
  s_cbranch_vccnz L_poll2
  v_mul_f32 v10, v116, v108
  v_mul_f32 v11, v116, v109
  v_mul_f32 v12, v116, v110
  v_fmac_f32 v10, v120, v112
  v_fmac_f32 v11, v120, v113
  v_fmac_f32 v12, v120, v114
L_final:
  s_nop 1
  v_permlane32_swap_b32 v10, v11
  v_permlane32_swap_b32 v12, v13
  v_add_f32 v10, v10, v11
  v_add_f32 v12, v12, v13
  s_nop 1
  v_permlane16_swap_b32 v10, v12
  v_add_f32 v10, v10, v12
  s_nop 1
  v_add_f32_dpp v10, v10, v10 row_ror:8 row_mask:0xf bank_mask:0xf
  v_fmac_f32 v10, v7, v75
  s_nop 0
  v_readlane_b32 s72, v10, 48
  s_nop 1
  v_rcp_f32 v11, s72
  s_nop 0
  v_mul_f32 v10, v10, v11
  v_cvt_pk_bf16_f32 v10, v10, v10
  buffer_store_short v10, v20, s[48:51], 0 offen
  s_endpgm
L_poll4:
  s_cmp_lt_u32 s73, 0x3fffc0
  s_cbranch_scc1 L_polls4
  buffer_load_dwordx4 v[124:127], v19, s[36:39], s63 offen offset:0 nt
  buffer_load_dwordx4 v[128:131], v19, s[36:39], s63 offen offset:128 nt
  buffer_load_dwordx4 v[132:135], v19, s[36:39], s63 offen offset:256 nt
  buffer_load_dwordx4 v[136:139], v19, s[36:39], s63 offen offset:384 nt
  s_add_u32 s72, s62, 0
  buffer_load_dwordx4 v[108:111], v18, s[44:47], s72 offen nt
  s_add_u32 s72, s62, 8192
  buffer_load_dwordx4 v[112:115], v18, s[44:47], s72 offen nt
  s_add_u32 s72, s62, 16384
  buffer_load_dwordx4 v[116:119], v18, s[44:47], s72 offen nt
  s_add_u32 s72, s62, 24576
  buffer_load_dwordx4 v[120:123], v18, s[44:47], s72 offen nt
L_pollc4:
  s_sub_u32 s73, s73, 1
  s_cbranch_scc1 L_fin
  s_waitcnt vmcnt(4)
  v_max3_f32 v7, v5, v124, v128
  v_max3_f32 v7, v7, v132, v136
  v_xor_b32 v127, s30, v127
  v_xor_b32 v131, s30, v131
  v_xor_b32 v135, s30, v135
  v_xor_b32 v139, s30, v139
  v_max_f32_dpp v7, v7, v7 row_ror:8 row_mask:0xf bank_mask:0xf
  v_mov_b32 v8, v7
  v_mov_b32 v9, v7
  s_nop 1
  v_permlane16_swap_b32 v8, v9
  v_max_f32 v7, v8, v9
  v_mov_b32 v8, v7
  v_mov_b32 v9, v7
  s_nop 1
  v_permlane32_swap_b32 v8, v9
  v_max_f32 v7, v8, v9
  v_mul_f32 v7, s56, v7
  v_fma_f32 v124, v124, s56, -v7
  v_fma_f32 v128, v128, s56, -v7
  v_fma_f32 v132, v132, s56, -v7
  v_fma_f32 v136, v136, s56, -v7
  v_fma_f32 v7, v5, s56, -v7
  v_exp_f32 v124, v124
  v_exp_f32 v128, v128
  v_exp_f32 v132, v132
  v_exp_f32 v136, v136
  v_exp_f32 v7, v7
  v_or_b32 v6, v127, v131
  v_or3_b32 v6, v6, v135, v139
  v_mul_f32 v13, v124, v125
  v_fmac_f32 v13, v128, v129
  v_fmac_f32 v13, v132, v133
  v_fmac_f32 v13, v136, v137
  s_waitcnt vmcnt(0)
  v_xor_b32 v111, s30, v111
  v_xor_b32 v115, s30, v115
  v_xor_b32 v119, s30, v119
  v_xor_b32 v123, s30, v123
  v_or3_b32 v6, v6, v111, v115
  v_or3_b32 v6, v6, v119, v123
  v_cmp_ne_u32 vcc, 0, v6
  s_cbranch_vccnz L_poll4
  v_mul_f32 v10, v124, v108
  v_mul_f32 v11, v124, v109
  v_mul_f32 v12, v124, v110
  v_fmac_f32 v10, v128, v112
  v_fmac_f32 v11, v128, v113
  v_fmac_f32 v12, v128, v114
  v_fmac_f32 v10, v132, v116
  v_fmac_f32 v11, v132, v117
  v_fmac_f32 v12, v132, v118
  v_fmac_f32 v10, v136, v120
  v_fmac_f32 v11, v136, v121
  v_fmac_f32 v12, v136, v122
  s_branch L_final
L_slow:
  s_cmp_lg_u32 s30, 0
  s_cbranch_scc1 L_havetag
  buffer_load_dword v73, off, s[44:47], 0 offset:12 sc1
  s_mov_b32 s72, 0
  buffer_load_dword v108, v17, s[36:39], s72 offen offset:12 sc1
  s_mov_b32 s72, 8192
  buffer_load_dword v109, v17, s[36:39], s72 offen offset:12 sc1
  s_mov_b32 s72, 16384
  buffer_load_dword v110, v17, s[36:39], s72 offen offset:12 sc1
  s_mov_b32 s72, 24576
  buffer_load_dword v111, v17, s[36:39], s72 offen offset:12 sc1
  s_mov_b32 s72, 32768
  buffer_load_dword v112, v17, s[36:39], s72 offen offset:12 sc1
  s_waitcnt vmcnt(0) lgkmcnt(0)
  v_readfirstlane_b32 s80, v73
  s_nop 0
  s_mul_i32 s30, s80, 0x9e3779b1
  s_add_u32 s30, s30, 0x7f4a7c13
  s_or_b32 s30, s30, 1
L_pick2:
  s_add_u32 s30, s30, 2
  s_cmp_eq_u32 s30, s80
  s_cbranch_scc1 L_pick2
  v_cmp_eq_u32 vcc, s30, v108
  s_cbranch_vccnz L_pick2
  v_cmp_eq_u32 vcc, s30, v109
  s_cbranch_vccnz L_pick2
  v_cmp_eq_u32 vcc, s30, v110
  s_cbranch_vccnz L_pick2
  v_cmp_eq_u32 vcc, s30, v111
  s_cbranch_vccnz L_pick2
  v_cmp_eq_u32 vcc, s30, v112
  s_cbranch_vccnz L_pick2
  s_mov_b32 s78, s30
  s_mov_b32 s79, 0
  s_atomic_cmpswap s[78:79], s[76:77], 0 glc
  s_waitcnt lgkmcnt(0)
  s_cmp_lg_u32 s78, 0
  s_cselect_b32 s30, s78, s30
L_havetag:
  s_waitcnt vmcnt(0)
  v_mov_b32 v83, s30
  s_cmp_eq_u32 s16, 0
  s_cbranch_scc1 L_sl5
  s_mov_b32 s17, 0
  s_mov_b64 exec, s[16:17]
  buffer_store_dwordx4 v[80:83], v16, s[36:39], 0 offen sc1
  s_mov_b64 exec, -1
  v_mov_b32 v91, s30
  s_sub_u32 s28, s28, 524288
  s_bitcmp1_b32 s16, 4
  s_cbranch_scc0 L_sl0
  buffer_store_dwordx4 v[88:91], v17, s[44:47], s28 offen sc1
L_sl0:
  v_mov_b32 v95, s30
  s_sub_u32 s28, s28, 524288
  s_bitcmp1_b32 s16, 3
  s_cbranch_scc0 L_sl1
  buffer_store_dwordx4 v[92:95], v17, s[44:47], s28 offen sc1
L_sl1:
  v_mov_b32 v99, s30
  s_sub_u32 s28, s28, 524288
  s_bitcmp1_b32 s16, 2
  s_cbranch_scc0 L_sl2
  buffer_store_dwordx4 v[96:99], v17, s[44:47], s28 offen sc1
L_sl2:
  v_mov_b32 v103, s30
  s_sub_u32 s28, s28, 524288
  s_bitcmp1_b32 s16, 1
  s_cbranch_scc0 L_sl3
  buffer_store_dwordx4 v[100:103], v17, s[44:47], s28 offen sc1
L_sl3:
  v_mov_b32 v107, s30
  s_sub_u32 s28, s28, 524288
  s_bitcmp1_b32 s16, 0
  s_cbranch_scc0 L_sl4
  buffer_store_dwordx4 v[104:107], v17, s[44:47], s28 offen sc1
L_sl4:
L_sl5:
  s_mov_b32 s73, 0x3fff00
  s_branch L_comb
L_polls2:
  buffer_load_dwordx4 v[116:119], v19, s[36:39], s63 offen offset:0 sc1
  buffer_load_dwordx4 v[120:123], v19, s[36:39], s63 offen offset:128 sc1
  s_add_u32 s72, s62, 0
  buffer_load_dwordx4 v[108:111], v18, s[44:47], s72 offen sc1
  s_add_u32 s72, s62, 8192
  buffer_load_dwordx4 v[112:115], v18, s[44:47], s72 offen sc1
  s_branch L_pollc2
L_polls4:
  buffer_load_dwordx4 v[124:127], v19, s[36:39], s63 offen offset:0 sc1
  buffer_load_dwordx4 v[128:131], v19, s[36:39], s63 offen offset:128 sc1
  buffer_load_dwordx4 v[132:135], v19, s[36:39], s63 offen offset:256 sc1
  buffer_load_dwordx4 v[136:139], v19, s[36:39], s63 offen offset:384 sc1
  s_add_u32 s72, s62, 0
  buffer_load_dwordx4 v[108:111], v18, s[44:47], s72 offen sc1
  s_add_u32 s72, s62, 8192
  buffer_load_dwordx4 v[112:115], v18, s[44:47], s72 offen sc1
  s_add_u32 s72, s62, 16384
  buffer_load_dwordx4 v[116:119], v18, s[44:47], s72 offen sc1
  s_add_u32 s72, s62, 24576
  buffer_load_dwordx4 v[120:123], v18, s[44:47], s72 offen sc1
  s_branch L_pollc4
L_pf:
  buffer_load_dword v21, v19, s[36:39], s63 offen offset:0 nt
  buffer_load_dword v21, v19, s[36:39], s63 offen offset:128 nt
  s_add_u32 s72, s62, 0
  buffer_load_dword v21, v18, s[44:47], s72 offen nt
  s_add_u32 s72, s62, 8192
  buffer_load_dword v21, v18, s[44:47], s72 offen nt
  s_cmp_eq_u32 s101, 0
  s_cbranch_scc1 L_pfd
  buffer_load_dword v21, v19, s[36:39], s63 offen offset:256 nt
  buffer_load_dword v21, v19, s[36:39], s63 offen offset:384 nt
  s_add_u32 s72, s62, 16384
  buffer_load_dword v21, v18, s[44:47], s72 offen nt
  s_add_u32 s72, s62, 24576
  buffer_load_dword v21, v18, s[44:47], s72 offen nt
  s_branch L_nopf
L_pfd:
  buffer_load_dword v21, v17, s[40:43], 0 offen offset:16
  buffer_load_dword v21, v17, s[40:43], 0 offen offset:16
  buffer_load_dword v21, v17, s[40:43], 0 offen offset:16
  buffer_load_dword v21, v17, s[40:43], 0 offen offset:16
  s_branch L_nopf
L_wink:
  s_add_u32 s68, s97, 125829120
  s_mov_b32 s23, 393216
  s_cmp_eq_u32 s71, 12
  s_cbranch_scc1 L_winrk
  s_add_u32 s68, s97, 100663296
  s_mov_b32 s23, 393216
  s_cmp_eq_u32 s71, 10
  s_cbranch_scc1 L_winrk
  s_add_u32 s68, s70, 50331648
  s_mov_b32 s23, 196608
  s_cmp_eq_u32 s71, 8
  s_cbranch_scc1 L_winrk
  s_add_u32 s68, s70, 0
  s_mov_b32 s23, 196608
  s_cmp_eq_u32 s71, 4
  s_cbranch_scc1 L_winrk
  s_mov_b32 s24, s8
  s_mov_b32 s25, s9
  s_add_u32 s68, s70, 150994944
  s_mov_b32 s23, 196608
  s_branch L_winrk
L_winv:
  s_add_u32 s68, s97, 125829120
  s_mov_b32 s23, 393216
  s_cmp_eq_u32 s71, 12
  s_cbranch_scc1 L_winrv
  s_add_u32 s68, s97, 100663296
  s_mov_b32 s23, 393216
  s_cmp_eq_u32 s71, 10
  s_cbranch_scc1 L_winrv
  s_add_u32 s68, s70, 50331648
  s_mov_b32 s23, 196608
  s_cmp_eq_u32 s71, 8
  s_cbranch_scc1 L_winrv
  s_add_u32 s68, s70, 0
  s_mov_b32 s23, 196608
  s_cmp_eq_u32 s71, 4
  s_cbranch_scc1 L_winrv
  s_branch L_winrv
L_xak:
  s_sub_u32 s3, s3, 1
  s_cmp_eq_u32 s3, 11
  s_cselect_b32 s79, s72, s79
  s_cmp_eq_u32 s3, 9
  s_cbranch_scc0 L_xdk
  s_cmp_le_u32 s75, 9
  s_cbranch_scc1 L_xdk
  s_cmp_gt_u32 s75, 24
  s_cbranch_scc1 L_xdk
  s_lshl_b32 s80, s59, 8
  s_mul_i32 s79, s79, 43
  s_sub_i32 s80, s80, s79
  s_add_i32 s80, s80, 3056
  s_mov_b32 s59, 0
  s_movk_i32 s79, 204
  s_cmp_gt_u32 s75, 12
  s_cselect_b32 s79, 358, s79
  s_mul_i32 s80, s80, s79
  s_ashr_i32 s31, s31, 8
  s_mul_i32 s31, s31, -128
  s_add_i32 s31, s31, s80
  s_min_i32 s31, s31, 2621440
  s_max_i32 s31, s31, -1966080
  s_and_b32 s31, s31, 0xffff0000
L_xdk:
  s_cmp_le_u32 s3, 2
  s_cselect_b32 s69, 1, 0
  s_cmp_gt_u32 s3, 9
  s_cselect_b32 s69, 1, s69
  s_cmp_lt_u32 s75, 7
  s_cselect_b32 s69, 0, s69
  s_cmp_gt_u32 s75, 24
  s_cselect_b32 s69, 0, s69
  s_cmp_eq_u32 s3, 0
  s_cbranch_scc0 L_xck
  s_mov_b32 s3, 12
  s_cmp_gt_u32 s75, 21
  s_cbranch_scc1 L_xck
  s_add_u32 s80, s98, s75
  v_mov_b32 v8, s80
  s_lshl_b32 s80, s2, 2
  v_lshlrev_b32 v9, 12, v0
  buffer_store_dword v8, v9, s[32:35], s80 offen sc1
  s_branch L_xck
L_xav:
  s_sub_u32 s3, s3, 1
  s_cmp_eq_u32 s3, 11
  s_cselect_b32 s79, s72, s79
  s_cmp_eq_u32 s3, 9
  s_cbranch_scc0 L_xdv
  s_cmp_le_u32 s75, 9
  s_cbranch_scc1 L_xdv
  s_cmp_gt_u32 s75, 24
  s_cbranch_scc1 L_xdv
  s_lshl_b32 s80, s59, 8
  s_mul_i32 s79, s79, 43
  s_sub_i32 s80, s80, s79
  s_add_i32 s80, s80, 3056
  s_mov_b32 s59, 0
  s_movk_i32 s79, 204
  s_cmp_gt_u32 s75, 12
  s_cselect_b32 s79, 358, s79
  s_mul_i32 s80, s80, s79
  s_ashr_i32 s31, s31, 8
  s_mul_i32 s31, s31, -128
  s_add_i32 s31, s31, s80
  s_min_i32 s31, s31, 2621440
  s_max_i32 s31, s31, -1966080
  s_and_b32 s31, s31, 0xffff0000
L_xdv:
  s_cmp_le_u32 s3, 2
  s_cselect_b32 s69, 1, 0
  s_cmp_gt_u32 s3, 9
  s_cselect_b32 s69, 1, s69
  s_cmp_lt_u32 s75, 7
  s_cselect_b32 s69, 0, s69
  s_cmp_gt_u32 s75, 24
  s_cselect_b32 s69, 0, s69
  s_cmp_eq_u32 s3, 0
  s_cbranch_scc0 L_xcv
  s_mov_b32 s3, 12
  s_cmp_gt_u32 s75, 21
  s_cbranch_scc1 L_xcv
  s_add_u32 s80, s98, s75
  v_mov_b32 v8, s80
  s_lshl_b32 s80, s2, 2
  v_lshlrev_b32 v9, 12, v0
  buffer_store_dword v8, v9, s[32:35], s80 offen sc1
  s_branch L_xcv
L_xsk0:
  s_waitcnt vmcnt(24)
  v_sub_u32 v10, v76, v72
  s_nop 0
  v_readlane_b32 s80, v10, s2
  buffer_load_dword v76, v14, s[32:35], 0 offen sc1
  s_nop 0
  v_cmp_lt_u32 vcc, s80, v10
  s_and_b32 s72, vcc_lo, 0xff
  s_bcnt1_i32_b32 s72, s72
  v_cmp_gt_u32 vcc, s80, v10
  s_add_i32 s59, s59, s72
  s_and_b32 s72, vcc_lo, 0xff
  s_bcnt1_i32_b32 s72, s72
  s_sub_i32 s59, s59, s72
  s_branch L_xrk0
L_xsk1:
  s_waitcnt vmcnt(24)
  v_sub_u32 v10, v77, v72
  s_nop 0
  v_readlane_b32 s80, v10, s2
  buffer_load_dword v77, v14, s[32:35], 0 offen sc1
  s_nop 0
  v_cmp_lt_u32 vcc, s80, v10
  s_and_b32 s72, vcc_lo, 0xff
  s_bcnt1_i32_b32 s72, s72
  v_cmp_gt_u32 vcc, s80, v10
  s_add_i32 s59, s59, s72
  s_and_b32 s72, vcc_lo, 0xff
  s_bcnt1_i32_b32 s72, s72
  s_sub_i32 s59, s59, s72
  s_branch L_xrk1
L_xsk2:
  s_waitcnt vmcnt(24)
  v_sub_u32 v10, v78, v72
  s_nop 0
  v_readlane_b32 s80, v10, s2
  buffer_load_dword v78, v14, s[32:35], 0 offen sc1
  s_nop 0
  v_cmp_lt_u32 vcc, s80, v10
  s_and_b32 s72, vcc_lo, 0xff
  s_bcnt1_i32_b32 s72, s72
  v_cmp_gt_u32 vcc, s80, v10
  s_add_i32 s59, s59, s72
  s_and_b32 s72, vcc_lo, 0xff
  s_bcnt1_i32_b32 s72, s72
  s_sub_i32 s59, s59, s72
  s_branch L_xrk2
L_xsk3:
  s_waitcnt vmcnt(24)
  v_sub_u32 v10, v79, v72
  s_nop 0
  v_readlane_b32 s80, v10, s2
  buffer_load_dword v79, v14, s[32:35], 0 offen sc1
  s_nop 0
  v_cmp_lt_u32 vcc, s80, v10
  s_and_b32 s72, vcc_lo, 0xff
  s_bcnt1_i32_b32 s72, s72
  v_cmp_gt_u32 vcc, s80, v10
  s_add_i32 s59, s59, s72
  s_and_b32 s72, vcc_lo, 0xff
  s_bcnt1_i32_b32 s72, s72
  s_sub_i32 s59, s59, s72
  s_branch L_xrk3
L_xsv0:
  s_waitcnt vmcnt(24)
  v_sub_u32 v10, v76, v72
  s_nop 0
  v_readlane_b32 s80, v10, s2
  buffer_load_dword v76, v14, s[32:35], 0 offen sc1
  s_nop 0
  v_cmp_lt_u32 vcc, s80, v10
  s_and_b32 s72, vcc_lo, 0xff
  s_bcnt1_i32_b32 s72, s72
  v_cmp_gt_u32 vcc, s80, v10
  s_add_i32 s59, s59, s72
  s_and_b32 s72, vcc_lo, 0xff
  s_bcnt1_i32_b32 s72, s72
  s_sub_i32 s59, s59, s72
  s_branch L_xrv0
L_xsv1:
  s_waitcnt vmcnt(24)
  v_sub_u32 v10, v77, v72
  s_nop 0
  v_readlane_b32 s80, v10, s2
  buffer_load_dword v77, v14, s[32:35], 0 offen sc1
  s_nop 0
  v_cmp_lt_u32 vcc, s80, v10
  s_and_b32 s72, vcc_lo, 0xff
  s_bcnt1_i32_b32 s72, s72
  v_cmp_gt_u32 vcc, s80, v10
  s_add_i32 s59, s59, s72
  s_and_b32 s72, vcc_lo, 0xff
  s_bcnt1_i32_b32 s72, s72
  s_sub_i32 s59, s59, s72
  s_branch L_xrv1
L_xsv2:
  s_waitcnt vmcnt(24)
  v_sub_u32 v10, v78, v72
  s_nop 0
  v_readlane_b32 s80, v10, s2
  buffer_load_dword v78, v14, s[32:35], 0 offen sc1
  s_nop 0
  v_cmp_lt_u32 vcc, s80, v10
  s_and_b32 s72, vcc_lo, 0xff
  s_bcnt1_i32_b32 s72, s72
  v_cmp_gt_u32 vcc, s80, v10
  s_add_i32 s59, s59, s72
  s_and_b32 s72, vcc_lo, 0xff
  s_bcnt1_i32_b32 s72, s72
  s_sub_i32 s59, s59, s72
  s_branch L_xrv2
L_xsv3:
  s_waitcnt vmcnt(24)
  v_sub_u32 v10, v79, v72
  s_nop 0
  v_readlane_b32 s80, v10, s2
  buffer_load_dword v79, v14, s[32:35], 0 offen sc1
  s_nop 0
  v_cmp_lt_u32 vcc, s80, v10
  s_and_b32 s72, vcc_lo, 0xff
  s_bcnt1_i32_b32 s72, s72
  v_cmp_gt_u32 vcc, s80, v10
  s_add_i32 s59, s59, s72
  s_and_b32 s72, vcc_lo, 0xff
  s_bcnt1_i32_b32 s72, s72
  s_sub_i32 s59, s59, s72
  s_branch L_xrv3
L_fin:
L_end:
  s_endpgm
.section .rodata,"a"
.p2align 6
.amdhsa_kernel standalone__tree_speculative_verify_tree_attention_over_candidate_token_tree__decode_kernel
  .amdhsa_next_free_vgpr 206
  .amdhsa_next_free_sgpr 102
  .amdhsa_accum_offset 208
  .amdhsa_group_segment_fixed_size 0
  .amdhsa_kernarg_size 72
  .amdhsa_user_sgpr_count 2
  .amdhsa_user_sgpr_kernarg_segment_ptr 1
  .amdhsa_system_sgpr_workgroup_id_x 1
.end_amdhsa_kernel
```
